```python
import torch

def _softmax(x, axis=-1):
    return torch.softmax(x, dim=axis)
def _gelu(x):
    return torch.nn.functional.gelu(x, approximate="tanh")
def _silu(x):
    return torch.nn.functional.silu(x)
def _sigmoid(x):
    return torch.sigmoid(x)
def _layernorm(x, axis=-1, eps=1e-5):
    m = x.mean(dim=axis, keepdim=True)
    v = x.var(dim=axis, keepdim=True, unbiased=False)
    return (x - m) / torch.sqrt(v + eps)
def _scatter_add(tgt, idx, src, axis=0):
    return tgt.clone().index_add_(axis, idx, src)
def _segment_sum(src, seg, n):
    out = torch.zeros((n,) + src.shape[1:], dtype=src.dtype)
    return out.index_add_(0, seg, src)
def _pad(x, pw):
    flat = tuple(v for pair in reversed(pw) for v in pair)
    return torch.nn.functional.pad(x, flat)

kernel_name = 'parallel_sum__gqa_block_cached__swiglu_ffn__decode'

def setup_inputs():

    _w = (lambda a: (lambda t: t.to(torch.bfloat16) if t.is_floating_point() else t)(torch.as_tensor(a)))
    def _A_setup():
        B, Sq, D = 1, 1, 576
        Hq, Hkv, Sk, Dh = 32, 16, 8192, 128
        assert Hq % Hkv == 0, (Hq, Hkv)
        return {
            "x": _w((lambda *s: torch.randn(*s, dtype=torch.bfloat16) * 0.05)(B, Sq, D)),
            "k_cache": _w((lambda *s: torch.randn(*s, dtype=torch.bfloat16) * 3.2)(B, Hkv, Sk, Dh)),
            "v_cache": _w((lambda *s: torch.randn(*s, dtype=torch.bfloat16) * 1.6)(B, Hkv, Sk, Dh)),
            "wq": _w((lambda *s: torch.randn(*s, dtype=torch.bfloat16) * 3.2)(D, Hq * Dh) * (D ** -0.5)),
            "wo": _w((lambda *s: torch.randn(*s, dtype=torch.bfloat16) * 1.6)(Hq * Dh, D) * ((Hq * Dh) ** -0.5)),
        }
    _A_in = _A_setup()

    def _B_setup():
        B, S, D, F = 1, 1, 576, 4608
        return {
            "x": _w((lambda *s: torch.randn(*s, dtype=torch.bfloat16) * 0.05)(B, S, D)),
            "w_gate": _w((lambda *s: torch.randn(*s, dtype=torch.bfloat16) * 0.05)(D, F)),
            "w_up": _w((lambda *s: torch.randn(*s, dtype=torch.bfloat16) * 0.05)(D, F)),
            "w_down": _w((lambda *s: torch.randn(*s, dtype=torch.bfloat16) * 0.05)(F, D)),
        }
    _B_in = _B_setup()

    return {
        "A_x": _A_in["x"],
        "A_k_cache": _A_in["k_cache"],
        "A_v_cache": _A_in["v_cache"],
        "A_wq": _A_in["wq"],
        "A_wo": _A_in["wo"],
        "B_x": _B_in["x"],
        "B_w_gate": _B_in["w_gate"],
        "B_w_up": _B_in["w_up"],
        "B_w_down": _B_in["w_down"],
    }

def reference(A_x, A_k_cache, A_v_cache, A_wq, A_wo, B_x, B_w_gate, B_w_up, B_w_down):
    def _A_ref(x, k_cache, v_cache, wq, wo):
        B, Sq, D = x.shape
        Hq, Dh = 32, 128
        Hkv = k_cache.shape[1]
        rep = Hq // Hkv
        q = (lambda x, *d: x.permute(*d))((x @ wq).reshape(B, Sq, Hq, Dh), 0, 2, 1, 3)
        k = (lambda x, n, axis: torch.repeat_interleave(x, n, dim=axis))(k_cache, rep, axis=1)
        v = (lambda x, n, axis: torch.repeat_interleave(x, n, dim=axis))(v_cache, rep, axis=1)
        scores = torch.einsum("bhqd,bhkd->bhqk", q, k) * (Dh ** -0.5)
        p = _softmax(scores, axis=-1)
        o = torch.einsum("bhqk,bhkd->bhqd", p, v)
        return (lambda x, *d: x.permute(*d))(o, 0, 2, 1, 3).reshape(B, Sq, Hq * Dh) @ wo

    def _B_ref(x, w_gate, w_up, w_down):
        g = _silu(x @ w_gate)
        u = x @ w_up
        return (g * u) @ w_down

    x = A_x
    xn = _layernorm(x, axis=-1)
    return x + _A_ref(xn, A_k_cache, A_v_cache, A_wq, A_wo) + _B_ref(xn, B_w_gate, B_w_up, B_w_down)
```

```asm
; @launch grid=(256,1,1) block=(512,1,1) lds=163840
.amdgcn_target "amdgcn-amd-amdhsa--gfx950"
.text
.globl parallel_sum__gqa_block_cached__swiglu_ffn__decode_kernel
.p2align 8
.type parallel_sum__gqa_block_cached__swiglu_ffn__decode_kernel,@function
parallel_sum__gqa_block_cached__swiglu_ffn__decode_kernel:
    s_cmp_ge_u32 s2, 256
    s_cbranch_scc1 L_end
    s_load_dwordx16 s[4:19], s[0:1], 0
    s_load_dwordx8 s[20:27], s[0:1], 64
    v_and_b32 v1, 63, v0
    v_lshrrev_b32 v248, 6, v0
    s_nop 0
    v_readfirstlane_b32 s28, v248
    s_and_b32 s29, s2, 15
    s_lshr_b32 s30, s2, 4
    s_mov_b32 s70, 0x3db504f3
    s_mov_b32 s71, 0x3fb8aa3b
    s_mov_b32 s72, 0x3ae38e39
    s_mov_b32 s73, 0x3727c5ac
    s_mov_b32 s75, 0xffff0000
    v_lshlrev_b32 v2, 4, v1
    v_lshrrev_b32 v248, 4, v1
    v_and_b32 v249, 15, v1
    v_lshlrev_b32 v250, 8, v249
    v_lshl_add_u32 v3, v248, 4, v250
    v_lshlrev_b32 v250, 4, v249
    v_lshl_add_u32 v4, v248, 10, v250
    v_mov_b32 v252, 0
    v_mov_b32 v253, 0
    v_mov_b32 v254, 0
    v_mov_b32 v255, 0
    v_mov_b32 v251, 2560
    ds_write_b128 v251, v[252:255]
    v_and_b32 v251, 7, v1
    v_lshrrev_b32 v252, 1, v251
    v_and_b32 v251, 1, v251
    v_lshlrev_b32 v251, 4, v251
    v_mov_b32 v253, 0xffff
    v_lshlrev_b32 v253, v251, v253
    v_cmp_eq_u32 vcc, 0, v252
    s_nop 1
    v_cndmask_b32 v8, 0, v253, vcc
    v_cmp_eq_u32 vcc, 1, v252
    s_nop 1
    v_cndmask_b32 v9, 0, v253, vcc
    v_cmp_eq_u32 vcc, 2, v252
    s_nop 1
    v_cndmask_b32 v10, 0, v253, vcc
    v_cmp_eq_u32 vcc, 3, v252
    s_nop 1
    v_cndmask_b32 v11, 0, v253, vcc
    v_cmp_gt_u32 vcc, 216, v0
    s_mov_b64 s[80:81], vcc
    s_mul_i32 s65, s28, 3
    s_mul_i32 s66, s28, 5
    s_sub_u32 s66, s66, 8
    s_cmp_lt_u32 s28, 4
    s_cselect_b32 s65, s65, s66
    s_lshl_b32 s65, s65, 12
    s_add_u32 s95, s65, 32768
    s_lshl_b32 s60, s29, 21
    s_lshl_b32 s66, s30, 17
    s_add_u32 s60, s60, s66
    s_add_u32 s60, s60, s65
    s_add_u32 s61, s60, 4096
    s_add_u32 s62, s60, 8192
    s_add_u32 s63, s60, 12288
    s_add_u32 s64, s60, 16384
    s_lshl_b32 s82, s29, 17
    s_add_u32 s82, s82, 2097152
    s_waitcnt lgkmcnt(0)
    s_load_dword s31, s[26:27], 0
    s_mov_b32 s36, s6
    s_and_b32 s37, s7, 0xffff
    s_mov_b32 s38, 0x2000000
    s_mov_b32 s39, 0x20000
    s_mov_b32 s40, s8
    s_and_b32 s41, s9, 0xffff
    s_mov_b32 s42, 0x2000000
    s_mov_b32 s43, 0x20000
    s_mov_b32 s48, s26
    s_and_b32 s49, s27, 0xffff
    s_mov_b32 s50, 0x1000000
    s_mov_b32 s51, 0x20000
    s_barrier
    s_cmp_ge_u32 s28, 4
    s_cbranch_scc1 L_B
    s_setprio 3
    s_mov_b32 s32, s4
    s_and_b32 s33, s5, 0xffff
    s_mov_b32 s34, 0x480
    s_mov_b32 s35, 0x20000
    s_mov_b32 s44, s10
    s_and_b32 s45, s11, 0xffff
    s_mov_b32 s46, 0x480000
    s_mov_b32 s47, 0x20000
    v_mul_u32_u24 v224, 911, v0
    v_lshrrev_b32 v224, 16, v224
    v_mul_u32_u24 v250, 72, v224
    v_sub_u32 v7, v0, v250
    v_min_u32 v224, 2, v224
    s_cmp_lt_u32 s28, 3
    s_cselect_b32 s67, 5, 3
    v_lshrrev_b32 v250, 3, v1
    v_mul_u32_u24 v250, s67, v250
    s_lshr_b32 s65, s30, 2
    s_mul_i32 s65, s65, 144
    s_mul_i32 s66, s28, 40
    s_add_u32 s65, s65, s66
    v_add_u32 v6, s65, v250
    v_lshlrev_b32 v6, 2, v6
    v_and_b32 v251, 7, v1
    v_lshlrev_b32 v251, 4, v251
    v_lshl_add_u32 v5, v250, 13, v251
    s_lshl_b32 s94, s65, 13
    s_lshl_b32 s66, s29, 9
    s_add_u32 s94, s94, s66
    s_and_b32 s66, s30, 3
    s_lshl_b32 s66, s66, 7
    s_add_u32 s94, s94, s66
    s_cmp_ge_u32 s28, 3
    s_cbranch_scc1 L_now34
    s_add_u32 s66, s94, 24576
    s_add_u32 s67, s94, 32768
    buffer_load_dwordx4 v[188:191], v5, s[44:47], s66 offen nt
    buffer_load_dwordx4 v[192:195], v5, s[44:47], s67 offen nt
L_now34:
    buffer_load_dwordx4 v[32:35], v2, s[32:35], 0 offen
    buffer_load_dwordx4 v[36:39], v2, s[32:35], 0 offen offset:1024
    buffer_load_dwordx4 v[176:179], v5, s[44:47], s94 offen nt
    s_add_u32 s94, s94, 8192
    buffer_load_dwordx4 v[180:183], v5, s[44:47], s94 offen nt
    s_add_u32 s94, s94, 8192
    buffer_load_dwordx4 v[184:187], v5, s[44:47], s94 offen nt
    v_cmp_le_u32 vcc, 36, v7
    v_subrev_u32 v250, 36, v7
    s_nop 0
    v_cndmask_b32 v250, v7, v250, vcc
    v_mul_u32_u24 v251, 12, v224
    s_mul_i32 s65, s30, 36
    v_add_u32 v251, s65, v251
    s_movk_i32 s66, 9216
    v_lshlrev_b32 v250, 4, v250
    v_mad_u32_u24 v250, v251, s66, v250
    s_mul_i32 s66, s29, 576
    v_add_u32 v250, s66, v250
    v_lshlrev_b32 v227, 2, v251
    v_mov_b32 v252, s16
    v_mov_b32 v253, s18
    v_cndmask_b32 v228, v252, v253, vcc
    v_mov_b32 v252, s17
    v_mov_b32 v253, s19
    v_cndmask_b32 v229, v252, v253, vcc
    v_add_co_u32 v228, vcc, v228, v250
    s_nop 1
    v_addc_co_u32 v229, vcc, 0, v229, vcc
    global_load_dwordx4 v[128:131], v[228:229], off nt
    v_add_co_u32 v228, vcc, 9216, v228
    s_nop 1
    v_addc_co_u32 v229, vcc, 0, v229, vcc
    global_load_dwordx4 v[132:135], v[228:229], off nt
    v_add_co_u32 v228, vcc, 9216, v228
    s_nop 1
    v_addc_co_u32 v229, vcc, 0, v229, vcc
    global_load_dwordx4 v[136:139], v[228:229], off nt
    v_add_co_u32 v228, vcc, 9216, v228
    s_nop 1
    v_addc_co_u32 v229, vcc, 0, v229, vcc
    global_load_dwordx4 v[140:143], v[228:229], off nt
    v_add_co_u32 v228, vcc, 9216, v228
    s_nop 1
    v_addc_co_u32 v229, vcc, 0, v229, vcc
    global_load_dwordx4 v[144:147], v[228:229], off nt
    v_add_co_u32 v228, vcc, 9216, v228
    s_nop 1
    v_addc_co_u32 v229, vcc, 0, v229, vcc
    global_load_dwordx4 v[148:151], v[228:229], off nt
    v_add_co_u32 v228, vcc, 9216, v228
    s_nop 1
    v_addc_co_u32 v229, vcc, 0, v229, vcc
    global_load_dwordx4 v[152:155], v[228:229], off nt
    v_add_co_u32 v228, vcc, 9216, v228
    s_nop 1
    v_addc_co_u32 v229, vcc, 0, v229, vcc
    global_load_dwordx4 v[156:159], v[228:229], off nt
    v_add_co_u32 v228, vcc, 9216, v228
    s_nop 1
    v_addc_co_u32 v229, vcc, 0, v229, vcc
    global_load_dwordx4 v[160:163], v[228:229], off nt
    v_add_co_u32 v228, vcc, 9216, v228
    s_nop 1
    v_addc_co_u32 v229, vcc, 0, v229, vcc
    global_load_dwordx4 v[164:167], v[228:229], off nt
    v_add_co_u32 v228, vcc, 9216, v228
    s_nop 1
    v_addc_co_u32 v229, vcc, 0, v229, vcc
    global_load_dwordx4 v[168:171], v[228:229], off nt
    v_add_co_u32 v228, vcc, 9216, v228
    s_nop 1
    v_addc_co_u32 v229, vcc, 0, v229, vcc
    global_load_dwordx4 v[172:175], v[228:229], off nt
    s_mov_b32 s52, s20
    s_and_b32 s53, s21, 0xffff
    s_mov_b32 s54, 0x510000
    s_mov_b32 s55, 0x20000
    s_mov_b32 s96, s12
    s_and_b32 s97, s13, 0xffff
    s_mov_b32 s98, 0x480000
    s_mov_b32 s99, 0x20000
    s_movk_i32 s66, 6912
    v_lshlrev_b32 v248, 4, v7
    v_mad_u32_u24 v248, v224, s66, v248
    v_mov_b32 v249, 0x80000000
    v_cndmask_b32 v225, v249, v248, s[80:81]
    s_mul_i32 s77, s29, 288
    s_mul_i32 s66, s30, 18
    s_add_u32 s77, s77, s66
    s_mul_i32 s77, s77, 1152
    s_lshl_b32 s76, s29, 8
    s_lshl_b32 s66, s30, 4
    s_add_u32 s76, s76, s66
    s_mul_i32 s76, s76, 1152
    s_waitcnt vmcnt(15)
    v_lshlrev_b32 v40, 16, v32
    v_and_b32 v41, s75, v32
    v_lshlrev_b32 v42, 16, v33
    v_and_b32 v43, s75, v33
    v_lshlrev_b32 v44, 16, v34
    v_and_b32 v45, s75, v34
    v_lshlrev_b32 v46, 16, v35
    v_and_b32 v47, s75, v35
    v_lshlrev_b32 v48, 16, v36
    v_and_b32 v49, s75, v36
    v_lshlrev_b32 v50, 16, v37
    v_and_b32 v51, s75, v37
    v_lshlrev_b32 v52, 16, v38
    v_and_b32 v53, s75, v38
    v_lshlrev_b32 v54, 16, v39
    v_and_b32 v55, s75, v39
    v_add_f32 v56, v40, v41
    v_add_f32 v57, v42, v43
    v_add_f32 v58, v44, v45
    v_add_f32 v59, v46, v47
    v_add_f32 v60, v48, v49
    v_add_f32 v61, v50, v51
    v_add_f32 v62, v52, v53
    v_add_f32 v63, v54, v55
    v_add_f32 v56, v56, v60
    v_add_f32 v57, v57, v61
    v_add_f32 v58, v58, v62
    v_add_f32 v59, v59, v63
    v_add_f32 v56, v56, v58
    v_add_f32 v57, v57, v59
    v_add_f32 v72, v56, v57
    s_nop 1
    v_add_f32 v72, v72, v72 row_ror:8
    s_nop 1
    v_add_f32 v72, v72, v72 row_ror:4
    s_nop 1
    v_add_f32 v72, v72, v72 row_ror:2
    s_nop 1
    v_add_f32 v72, v72, v72 row_ror:1
    v_mov_b32 v73, v72
    s_nop 1
    v_permlane16_swap_b32 v72, v73
    v_add_f32 v72, v72, v73
    v_mov_b32 v73, v72
    s_nop 1
    v_permlane32_swap_b32 v72, v73
    v_add_f32 v72, v72, v73
    v_mul_f32 v72, s72, v72
    s_mov_b64 s[78:79], 0xff
    v_sub_f32 v56, v40, v72
    v_sub_f32 v57, v41, v72
    v_sub_f32 v58, v42, v72
    v_sub_f32 v59, v43, v72
    v_sub_f32 v60, v44, v72
    v_sub_f32 v61, v45, v72
    v_sub_f32 v62, v46, v72
    v_sub_f32 v63, v47, v72
    v_sub_f32 v64, v48, v72
    v_sub_f32 v65, v49, v72
    v_sub_f32 v66, v50, v72
    v_sub_f32 v67, v51, v72
    v_sub_f32 v68, v52, v72
    v_sub_f32 v69, v53, v72
    v_sub_f32 v70, v54, v72
    v_sub_f32 v71, v55, v72
    v_cndmask_b32 v64, 0, v64, s[78:79]
    v_cndmask_b32 v65, 0, v65, s[78:79]
    v_cndmask_b32 v66, 0, v66, s[78:79]
    v_cndmask_b32 v67, 0, v67, s[78:79]
    v_cndmask_b32 v68, 0, v68, s[78:79]
    v_cndmask_b32 v69, 0, v69, s[78:79]
    v_cndmask_b32 v70, 0, v70, s[78:79]
    v_cndmask_b32 v71, 0, v71, s[78:79]
    v_mul_f32 v73, v56, v56
    v_mul_f32 v74, v57, v57
    v_fmac_f32 v73, v58, v58
    v_fmac_f32 v74, v59, v59
    v_fmac_f32 v73, v60, v60
    v_fmac_f32 v74, v61, v61
    v_fmac_f32 v73, v62, v62
    v_fmac_f32 v74, v63, v63
    v_fmac_f32 v73, v64, v64
    v_fmac_f32 v74, v65, v65
    v_fmac_f32 v73, v66, v66
    v_fmac_f32 v74, v67, v67
    v_fmac_f32 v73, v68, v68
    v_fmac_f32 v74, v69, v69
    v_fmac_f32 v73, v70, v70
    v_fmac_f32 v74, v71, v71
    v_add_f32 v73, v73, v74
    s_nop 1
    v_add_f32 v73, v73, v73 row_ror:8
    s_nop 1
    v_add_f32 v73, v73, v73 row_ror:4
    s_nop 1
    v_add_f32 v73, v73, v73 row_ror:2
    s_nop 1
    v_add_f32 v73, v73, v73 row_ror:1
    v_mov_b32 v74, v73
    s_nop 1
    v_permlane16_swap_b32 v73, v74
    v_add_f32 v73, v73, v74
    v_mov_b32 v74, v73
    s_nop 1
    v_permlane32_swap_b32 v73, v74
    v_add_f32 v73, v73, v74
    v_mul_f32 v73, s72, v73
    v_cvt_pk_bf16_f32 v74, v72, v73
    v_lshlrev_b32 v72, 16, v74
    v_and_b32 v73, s75, v74
    v_add_f32 v73, s73, v73
    v_cvt_pk_bf16_f32 v73, v73, v73
    v_and_b32 v73, s75, v73
    v_sqrt_f32 v73, v73
    s_nop 0
    v_cvt_pk_bf16_f32 v73, v73, v73
    v_and_b32 v73, s75, v73
    v_rcp_f32 v74, v73
    v_sub_f32 v56, v40, v72
    v_sub_f32 v57, v41, v72
    v_sub_f32 v58, v42, v72
    v_sub_f32 v59, v43, v72
    v_sub_f32 v60, v44, v72
    v_sub_f32 v61, v45, v72
    v_sub_f32 v62, v46, v72
    v_sub_f32 v63, v47, v72
    v_sub_f32 v64, v48, v72
    v_sub_f32 v65, v49, v72
    v_sub_f32 v66, v50, v72
    v_sub_f32 v67, v51, v72
    v_sub_f32 v68, v52, v72
    v_sub_f32 v69, v53, v72
    v_sub_f32 v70, v54, v72
    v_sub_f32 v71, v55, v72
    v_cvt_pk_bf16_f32 v75, v56, v57
    v_lshlrev_b32 v56, 16, v75
    v_and_b32 v57, s75, v75
    v_cvt_pk_bf16_f32 v75, v58, v59
    v_lshlrev_b32 v58, 16, v75
    v_and_b32 v59, s75, v75
    v_cvt_pk_bf16_f32 v75, v60, v61
    v_lshlrev_b32 v60, 16, v75
    v_and_b32 v61, s75, v75
    v_cvt_pk_bf16_f32 v75, v62, v63
    v_lshlrev_b32 v62, 16, v75
    v_and_b32 v63, s75, v75
    v_cvt_pk_bf16_f32 v75, v64, v65
    v_lshlrev_b32 v64, 16, v75
    v_and_b32 v65, s75, v75
    v_cvt_pk_bf16_f32 v75, v66, v67
    v_lshlrev_b32 v66, 16, v75
    v_and_b32 v67, s75, v75
    v_cvt_pk_bf16_f32 v75, v68, v69
    v_lshlrev_b32 v68, 16, v75
    v_and_b32 v69, s75, v75
    v_cvt_pk_bf16_f32 v75, v70, v71
    v_lshlrev_b32 v70, 16, v75
    v_and_b32 v71, s75, v75
    v_mul_f32 v40, v56, v74
    v_mul_f32 v41, v57, v74
    v_mul_f32 v42, v58, v74
    v_mul_f32 v43, v59, v74
    v_mul_f32 v44, v60, v74
    v_mul_f32 v45, v61, v74
    v_mul_f32 v46, v62, v74
    v_mul_f32 v47, v63, v74
    v_mul_f32 v48, v64, v74
    v_mul_f32 v49, v65, v74
    v_mul_f32 v50, v66, v74
    v_mul_f32 v51, v67, v74
    v_mul_f32 v52, v68, v74
    v_mul_f32 v53, v69, v74
    v_mul_f32 v54, v70, v74
    v_mul_f32 v55, v71, v74
    v_fma_f32 v56, -v40, v73, v56
    v_fma_f32 v57, -v41, v73, v57
    v_fma_f32 v58, -v42, v73, v58
    v_fma_f32 v59, -v43, v73, v59
    v_fma_f32 v60, -v44, v73, v60
    v_fma_f32 v61, -v45, v73, v61
    v_fma_f32 v62, -v46, v73, v62
    v_fma_f32 v63, -v47, v73, v63
    v_fma_f32 v64, -v48, v73, v64
    v_fma_f32 v65, -v49, v73, v65
    v_fma_f32 v66, -v50, v73, v66
    v_fma_f32 v67, -v51, v73, v67
    v_fma_f32 v68, -v52, v73, v68
    v_fma_f32 v69, -v53, v73, v69
    v_fma_f32 v70, -v54, v73, v70
    v_fma_f32 v71, -v55, v73, v71
    v_fmac_f32 v40, v56, v74
    v_fmac_f32 v41, v57, v74
    v_fmac_f32 v42, v58, v74
    v_fmac_f32 v43, v59, v74
    v_fmac_f32 v44, v60, v74
    v_fmac_f32 v45, v61, v74
    v_fmac_f32 v46, v62, v74
    v_fmac_f32 v47, v63, v74
    v_fmac_f32 v48, v64, v74
    v_fmac_f32 v49, v65, v74
    v_fmac_f32 v50, v66, v74
    v_fmac_f32 v51, v67, v74
    v_fmac_f32 v52, v68, v74
    v_fmac_f32 v53, v69, v74
    v_fmac_f32 v54, v70, v74
    v_fmac_f32 v55, v71, v74
    v_cvt_pk_bf16_f32 v56, v40, v40
    v_cvt_pk_bf16_f32 v57, v41, v41
    v_cvt_pk_bf16_f32 v58, v42, v42
    v_cvt_pk_bf16_f32 v59, v43, v43
    v_cvt_pk_bf16_f32 v60, v44, v44
    v_cvt_pk_bf16_f32 v61, v45, v45
    v_cvt_pk_bf16_f32 v62, v46, v46
    v_cvt_pk_bf16_f32 v63, v47, v47
    v_cvt_pk_bf16_f32 v64, v48, v48
    v_cvt_pk_bf16_f32 v65, v49, v49
    v_cvt_pk_bf16_f32 v66, v50, v50
    v_cvt_pk_bf16_f32 v67, v51, v51
    v_cvt_pk_bf16_f32 v68, v52, v52
    v_cvt_pk_bf16_f32 v69, v53, v53
    v_cvt_pk_bf16_f32 v70, v54, v54
    v_cvt_pk_bf16_f32 v71, v55, v55
    v_lshlrev_b32 v72, 5, v1
    ds_write_b128 v72, v[56:59] offset:0
    ds_write_b128 v72, v[60:63] offset:16
    s_mov_b64 exec, 0xff
    ds_write_b128 v72, v[64:67] offset:2048
    ds_write_b128 v72, v[68:71] offset:2064
    s_mov_b64 exec, -1
    s_waitcnt lgkmcnt(0)
    s_add_u32 s31, s31, 1
    ds_read_b32 v32, v6 offset:0
    ds_read_b32 v33, v6 offset:4
    ds_read_b32 v34, v6 offset:8
    ds_read_b32 v35, v6 offset:12
    ds_read_b32 v36, v6 offset:16
    ds_read_b32 v37, v227 offset:0
    ds_read_b32 v38, v227 offset:4
    ds_read_b32 v39, v227 offset:8
    ds_read_b32 v40, v227 offset:12
    ds_read_b32 v41, v227 offset:16
    ds_read_b32 v42, v227 offset:20
    ds_read_b32 v43, v227 offset:24
    ds_read_b32 v44, v227 offset:28
    ds_read_b32 v45, v227 offset:32
    ds_read_b32 v46, v227 offset:36
    ds_read_b32 v47, v227 offset:40
    ds_read_b32 v48, v227 offset:44
    s_waitcnt lgkmcnt(0)
    v_and_b32 v52, v32, v8
    v_and_b32 v53, v32, v9
    v_and_b32 v54, v32, v10
    v_and_b32 v55, v32, v11
    v_and_b32 v56, v33, v8
    v_and_b32 v57, v33, v9
    v_and_b32 v58, v33, v10
    v_and_b32 v59, v33, v11
    v_and_b32 v60, v34, v8
    v_and_b32 v61, v34, v9
    v_and_b32 v62, v34, v10
    v_and_b32 v63, v34, v11
    v_and_b32 v64, v35, v8
    v_and_b32 v65, v35, v9
    v_and_b32 v66, v35, v10
    v_and_b32 v67, v35, v11
    v_and_b32 v68, v36, v8
    v_and_b32 v69, v36, v9
    v_and_b32 v70, v36, v10
    v_and_b32 v71, v36, v11
    v_and_b32 v37, s75, v37
    v_and_b32 v38, s75, v38
    v_and_b32 v39, s75, v39
    v_and_b32 v40, s75, v40
    v_and_b32 v41, s75, v41
    v_and_b32 v42, s75, v42
    v_and_b32 v43, s75, v43
    v_and_b32 v44, s75, v44
    v_and_b32 v45, s75, v45
    v_and_b32 v46, s75, v46
    v_and_b32 v47, s75, v47
    v_and_b32 v48, s75, v48
    s_waitcnt vmcnt(12)
    v_mfma_f32_16x16x32_bf16 v[12:15], v[176:179], v[52:55], 0
    v_mfma_f32_16x16x32_bf16 v[12:15], v[180:183], v[56:59], v[12:15]
    v_mfma_f32_16x16x32_bf16 v[12:15], v[184:187], v[60:63], v[12:15]
    s_cmp_ge_u32 s28, 3
    s_cbranch_scc1 L_nom34
    v_mfma_f32_16x16x32_bf16 v[12:15], v[188:191], v[64:67], v[12:15]
    v_mfma_f32_16x16x32_bf16 v[12:15], v[192:195], v[68:71], v[12:15]
L_nom34:
    s_waitcnt vmcnt(11)
    v_lshlrev_b32 v248, 16, v128
    v_and_b32 v249, s75, v128
    v_lshlrev_b32 v250, 16, v129
    v_and_b32 v251, s75, v129
    v_lshlrev_b32 v252, 16, v130
    v_and_b32 v253, s75, v130
    v_lshlrev_b32 v254, 16, v131
    v_and_b32 v255, s75, v131
    v_mul_f32 v240, v248, v37
    v_mul_f32 v241, v249, v37
    v_mul_f32 v242, v250, v37
    v_mul_f32 v243, v251, v37
    v_mul_f32 v244, v252, v37
    v_mul_f32 v245, v253, v37
    v_mul_f32 v246, v254, v37
    v_mul_f32 v247, v255, v37
    s_waitcnt vmcnt(10)
    v_lshlrev_b32 v248, 16, v132
    v_and_b32 v249, s75, v132
    v_lshlrev_b32 v250, 16, v133
    v_and_b32 v251, s75, v133
    v_lshlrev_b32 v252, 16, v134
    v_and_b32 v253, s75, v134
    v_lshlrev_b32 v254, 16, v135
    v_and_b32 v255, s75, v135
    v_fmac_f32 v240, v248, v38
    v_fmac_f32 v241, v249, v38
    v_fmac_f32 v242, v250, v38
    v_fmac_f32 v243, v251, v38
    v_fmac_f32 v244, v252, v38
    v_fmac_f32 v245, v253, v38
    v_fmac_f32 v246, v254, v38
    v_fmac_f32 v247, v255, v38
    s_waitcnt vmcnt(9)
    v_lshlrev_b32 v248, 16, v136
    v_and_b32 v249, s75, v136
    v_lshlrev_b32 v250, 16, v137
    v_and_b32 v251, s75, v137
    v_lshlrev_b32 v252, 16, v138
    v_and_b32 v253, s75, v138
    v_lshlrev_b32 v254, 16, v139
    v_and_b32 v255, s75, v139
    v_fmac_f32 v240, v248, v39
    v_fmac_f32 v241, v249, v39
    v_fmac_f32 v242, v250, v39
    v_fmac_f32 v243, v251, v39
    v_fmac_f32 v244, v252, v39
    v_fmac_f32 v245, v253, v39
    v_fmac_f32 v246, v254, v39
    v_fmac_f32 v247, v255, v39
    s_waitcnt vmcnt(8)
    v_lshlrev_b32 v248, 16, v140
    v_and_b32 v249, s75, v140
    v_lshlrev_b32 v250, 16, v141
    v_and_b32 v251, s75, v141
    v_lshlrev_b32 v252, 16, v142
    v_and_b32 v253, s75, v142
    v_lshlrev_b32 v254, 16, v143
    v_and_b32 v255, s75, v143
    v_fmac_f32 v240, v248, v40
    v_fmac_f32 v241, v249, v40
    v_fmac_f32 v242, v250, v40
    v_fmac_f32 v243, v251, v40
    v_fmac_f32 v244, v252, v40
    v_fmac_f32 v245, v253, v40
    v_fmac_f32 v246, v254, v40
    v_fmac_f32 v247, v255, v40
    s_waitcnt vmcnt(7)
    v_lshlrev_b32 v248, 16, v144
    v_and_b32 v249, s75, v144
    v_lshlrev_b32 v250, 16, v145
    v_and_b32 v251, s75, v145
    v_lshlrev_b32 v252, 16, v146
    v_and_b32 v253, s75, v146
    v_lshlrev_b32 v254, 16, v147
    v_and_b32 v255, s75, v147
    v_fmac_f32 v240, v248, v41
    v_fmac_f32 v241, v249, v41
    v_fmac_f32 v242, v250, v41
    v_fmac_f32 v243, v251, v41
    v_fmac_f32 v244, v252, v41
    v_fmac_f32 v245, v253, v41
    v_fmac_f32 v246, v254, v41
    v_fmac_f32 v247, v255, v41
    s_waitcnt vmcnt(6)
    v_lshlrev_b32 v248, 16, v148
    v_and_b32 v249, s75, v148
    v_lshlrev_b32 v250, 16, v149
    v_and_b32 v251, s75, v149
    v_lshlrev_b32 v252, 16, v150
    v_and_b32 v253, s75, v150
    v_lshlrev_b32 v254, 16, v151
    v_and_b32 v255, s75, v151
    v_fmac_f32 v240, v248, v42
    v_fmac_f32 v241, v249, v42
    v_fmac_f32 v242, v250, v42
    v_fmac_f32 v243, v251, v42
    v_fmac_f32 v244, v252, v42
    v_fmac_f32 v245, v253, v42
    v_fmac_f32 v246, v254, v42
    v_fmac_f32 v247, v255, v42
    s_waitcnt vmcnt(5)
    v_lshlrev_b32 v248, 16, v152
    v_and_b32 v249, s75, v152
    v_lshlrev_b32 v250, 16, v153
    v_and_b32 v251, s75, v153
    v_lshlrev_b32 v252, 16, v154
    v_and_b32 v253, s75, v154
    v_lshlrev_b32 v254, 16, v155
    v_and_b32 v255, s75, v155
    v_fmac_f32 v240, v248, v43
    v_fmac_f32 v241, v249, v43
    v_fmac_f32 v242, v250, v43
    v_fmac_f32 v243, v251, v43
    v_fmac_f32 v244, v252, v43
    v_fmac_f32 v245, v253, v43
    v_fmac_f32 v246, v254, v43
    v_fmac_f32 v247, v255, v43
    s_waitcnt vmcnt(4)
    v_lshlrev_b32 v248, 16, v156
    v_and_b32 v249, s75, v156
    v_lshlrev_b32 v250, 16, v157
    v_and_b32 v251, s75, v157
    v_lshlrev_b32 v252, 16, v158
    v_and_b32 v253, s75, v158
    v_lshlrev_b32 v254, 16, v159
    v_and_b32 v255, s75, v159
    v_fmac_f32 v240, v248, v44
    v_fmac_f32 v241, v249, v44
    v_fmac_f32 v242, v250, v44
    v_fmac_f32 v243, v251, v44
    v_fmac_f32 v244, v252, v44
    v_fmac_f32 v245, v253, v44
    v_fmac_f32 v246, v254, v44
    v_fmac_f32 v247, v255, v44
    s_waitcnt vmcnt(3)
    v_lshlrev_b32 v248, 16, v160
    v_and_b32 v249, s75, v160
    v_lshlrev_b32 v250, 16, v161
    v_and_b32 v251, s75, v161
    v_lshlrev_b32 v252, 16, v162
    v_and_b32 v253, s75, v162
    v_lshlrev_b32 v254, 16, v163
    v_and_b32 v255, s75, v163
    v_fmac_f32 v240, v248, v45
    v_fmac_f32 v241, v249, v45
    v_fmac_f32 v242, v250, v45
    v_fmac_f32 v243, v251, v45
    v_fmac_f32 v244, v252, v45
    v_fmac_f32 v245, v253, v45
    v_fmac_f32 v246, v254, v45
    v_fmac_f32 v247, v255, v45
    s_waitcnt vmcnt(2)
    v_lshlrev_b32 v248, 16, v164
    v_and_b32 v249, s75, v164
    v_lshlrev_b32 v250, 16, v165
    v_and_b32 v251, s75, v165
    v_lshlrev_b32 v252, 16, v166
    v_and_b32 v253, s75, v166
    v_lshlrev_b32 v254, 16, v167
    v_and_b32 v255, s75, v167
    v_fmac_f32 v240, v248, v46
    v_fmac_f32 v241, v249, v46
    v_fmac_f32 v242, v250, v46
    v_fmac_f32 v243, v251, v46
    v_fmac_f32 v244, v252, v46
    v_fmac_f32 v245, v253, v46
    v_fmac_f32 v246, v254, v46
    v_fmac_f32 v247, v255, v46
    s_waitcnt vmcnt(1)
    v_lshlrev_b32 v248, 16, v168
    v_and_b32 v249, s75, v168
    v_lshlrev_b32 v250, 16, v169
    v_and_b32 v251, s75, v169
    v_lshlrev_b32 v252, 16, v170
    v_and_b32 v253, s75, v170
    v_lshlrev_b32 v254, 16, v171
    v_and_b32 v255, s75, v171
    v_fmac_f32 v240, v248, v47
    v_fmac_f32 v241, v249, v47
    v_fmac_f32 v242, v250, v47
    v_fmac_f32 v243, v251, v47
    v_fmac_f32 v244, v252, v47
    v_fmac_f32 v245, v253, v47
    v_fmac_f32 v246, v254, v47
    v_fmac_f32 v247, v255, v47
    s_waitcnt vmcnt(0)
    v_lshlrev_b32 v248, 16, v172
    v_and_b32 v249, s75, v172
    v_lshlrev_b32 v250, 16, v173
    v_and_b32 v251, s75, v173
    v_lshlrev_b32 v252, 16, v174
    v_and_b32 v253, s75, v174
    v_lshlrev_b32 v254, 16, v175
    v_and_b32 v255, s75, v175
    v_fmac_f32 v240, v248, v48
    v_fmac_f32 v241, v249, v48
    v_fmac_f32 v242, v250, v48
    v_fmac_f32 v243, v251, v48
    v_fmac_f32 v244, v252, v48
    v_fmac_f32 v245, v253, v48
    v_fmac_f32 v246, v254, v48
    v_fmac_f32 v247, v255, v48
    s_lshl_b32 s65, s28, 10
    v_add_u32 v248, s65, v2
    ds_write_b128 v248, v[12:15] offset:4608
    v_lshlrev_b32 v249, 5, v0
    s_mov_b64 exec, s[80:81]
    ds_write_b128 v249, v[240:243] offset:25088
    ds_write_b128 v249, v[244:247] offset:25104
    s_mov_b64 exec, -1
    s_waitcnt lgkmcnt(0)
    v_mov_b32 v254, 1
    v_mov_b32 v255, 2560
    s_mov_b64 exec, 1
    ds_add_u32 v255, v254
    s_mov_b64 exec, -1
    v_mov_b32 v255, 2560
L_lw_s2:
    ds_read_b32 v254, v255
    s_waitcnt lgkmcnt(0)
    v_readfirstlane_b32 s68, v254
    s_cmp_ge_u32 s68, 4
    s_cbranch_scc1 L_lwok_s2
    s_sleep 1
    s_branch L_lw_s2
L_lwok_s2:
    s_lshl_b32 s65, s30, 13
    s_add_u32 s65, s65, s82
    v_lshlrev_b32 v248, 3, v0
    ds_read_b64 v[32:33], v248 offset:25088
    ds_read_b64 v[34:35], v248 offset:27392
    ds_read_b64 v[36:37], v248 offset:29696
    s_cmp_eq_u32 s28, 0
    s_cbranch_scc1 L_pubq
    v_and_b32 v249, 31, v1
    v_lshlrev_b32 v249, 3, v249
    ds_read_b64 v[38:39], v249 offset:27136
    ds_read_b64 v[40:41], v249 offset:29440
    ds_read_b64 v[42:43], v249 offset:31744
    s_waitcnt lgkmcnt(0)
    v_add_f32 v38, v38, v40
    v_add_f32 v52, v38, v42
    v_add_f32 v39, v39, v41
    v_add_f32 v54, v39, v43
    v_subrev_u32 v251, 64, v0
    v_lshlrev_b32 v250, 4, v251
    v_add_u32 v250, 6144, v250
    v_cmp_gt_u32 vcc, 32, v251
    v_mov_b32 v251, 0x80000000
    s_nop 0
    v_cndmask_b32 v250, v251, v250, vcc
    s_branch L_pubst
L_pubq:
    s_nop 7
    s_nop 1
    v_lshrrev_b32 v248, 5, v1
    v_and_b32 v249, 7, v1
    v_lshl_add_u32 v248, v248, 4, v249
    v_lshlrev_b32 v248, 4, v248
    v_bfe_u32 v249, v1, 3, 2
    v_lshl_add_u32 v248, v249, 2, v248
    v_add_u32 v248, 4608, v248
    v_add_u32 v249, 640, v248
    ds_read2st64_b32 v[38:39], v248 offset0:0 offset1:4
    ds_read2st64_b32 v[40:41], v248 offset0:8 offset1:12
    ds_read2st64_b32 v[42:43], v249 offset0:0 offset1:4
    ds_read2st64_b32 v[44:45], v249 offset0:8 offset1:12
    s_waitcnt lgkmcnt(0)
    v_add_f32 v38, v38, v42
    v_add_f32 v39, v39, v43
    v_add_f32 v40, v40, v44
    v_add_f32 v41, v41, v45
    v_add_f32 v38, v38, v39
    v_add_f32 v40, v40, v41
    v_add_f32 v52, v38, v40
    s_nop 1
    v_mov_b32 v54, v52 quad_perm:[1,1,3,3]
    v_lshlrev_b32 v250, 3, v1
    v_and_b32 v251, 1, v1
    v_cmp_eq_u32 vcc, 0, v251
    v_mov_b32 v251, 0x80000000
    s_nop 0
    v_cndmask_b32 v250, v251, v250, vcc
L_pubst:
    s_nop 7
    s_nop 1
    v_add_f32 v32, v32, v34
    v_add_f32 v48, v32, v36
    v_add_f32 v33, v33, v35
    v_add_f32 v50, v33, v37
    v_mov_b32 v49, s31
    v_mov_b32 v51, s31
    v_mov_b32 v53, s31
    v_mov_b32 v55, s31
    v_lshlrev_b32 v249, 4, v0
    s_mov_b32 s84, s65
    s_add_u32 s65, s65, 8388608
    v_mov_b32 v56, v250
    v_mov_b32 v57, v249
    buffer_store_dwordx4 v[52:55], v250, s[48:51], s65 offen
    buffer_store_dwordx4 v[48:51], v249, s[48:51], s65 offen offset:2048
    s_setprio 1
    v_lshrrev_b32 v248, 4, v1
    v_and_b32 v249, 15, v1
    v_lshlrev_b32 v250, 8, v248
    v_add_u32 v251, 0, v248
    v_xor_b32 v251, v251, v249
    v_lshl_add_u32 v220, v251, 4, v250
    v_add_u32 v251, 4, v248
    v_xor_b32 v251, v251, v249
    v_lshl_add_u32 v221, v251, 4, v250
    v_add_u32 v251, 8, v248
    v_xor_b32 v251, v251, v249
    v_lshl_add_u32 v222, v251, 4, v250
    v_add_u32 v251, 12, v248
    v_xor_b32 v251, v251, v249
    v_lshl_add_u32 v223, v251, 4, v250
    s_add_u32 m0, s95, 0
    s_nop 0
    buffer_load_dwordx4 v220, s[36:39], s60 offen offset:0 nt lds
    buffer_load_dwordx4 v221, s[36:39], s60 offen offset:1024 nt lds
    buffer_load_dwordx4 v222, s[36:39], s60 offen offset:2048 nt lds
    buffer_load_dwordx4 v223, s[36:39], s60 offen offset:3072 nt lds
    s_add_u32 m0, s95, 4096
    s_nop 0
    buffer_load_dwordx4 v220, s[36:39], s61 offen offset:0 nt lds
    buffer_load_dwordx4 v221, s[36:39], s61 offen offset:1024 nt lds
    buffer_load_dwordx4 v222, s[36:39], s61 offen offset:2048 nt lds
    buffer_load_dwordx4 v223, s[36:39], s61 offen offset:3072 nt lds
    s_add_u32 m0, s95, 8192
    s_nop 0
    buffer_load_dwordx4 v220, s[36:39], s62 offen offset:0 nt lds
    buffer_load_dwordx4 v221, s[36:39], s62 offen offset:1024 nt lds
    buffer_load_dwordx4 v222, s[36:39], s62 offen offset:2048 nt lds
    buffer_load_dwordx4 v223, s[36:39], s62 offen offset:3072 nt lds
    buffer_load_dwordx4 v[80:83], v4, s[40:43], s60 offen offset:0 nt
    buffer_load_dwordx4 v[84:87], v4, s[40:43], s60 offen offset:256 nt
    buffer_load_dwordx4 v[88:91], v4, s[40:43], s60 offen offset:512 nt
    buffer_load_dwordx4 v[92:95], v4, s[40:43], s60 offen offset:768 nt
    buffer_load_dwordx4 v[96:99], v4, s[40:43], s61 offen offset:0 nt
    buffer_load_dwordx4 v[100:103], v4, s[40:43], s61 offen offset:256 nt
    buffer_load_dwordx4 v[104:107], v4, s[40:43], s61 offen offset:512 nt
    buffer_load_dwordx4 v[108:111], v4, s[40:43], s61 offen offset:768 nt
    buffer_load_dwordx4 v[112:115], v4, s[40:43], s62 offen offset:0 nt
    buffer_load_dwordx4 v[116:119], v4, s[40:43], s62 offen offset:256 nt
    buffer_load_dwordx4 v[120:123], v4, s[40:43], s62 offen offset:512 nt
    buffer_load_dwordx4 v[124:127], v4, s[40:43], s62 offen offset:768 nt
    s_setprio 0
    buffer_store_dwordx4 v[52:55], v56, s[48:51], s84 offen sc1
    buffer_store_dwordx4 v[48:51], v57, s[48:51], s84 offen offset:2048 sc1
    v_mov_b32 v255, 2564
L_lw_s3a:
    ds_read_b32 v254, v255
    s_waitcnt lgkmcnt(0)
    v_readfirstlane_b32 s68, v254
    s_cmp_ge_u32 s68, 4
    s_cbranch_scc1 L_lwok_s3a
    s_sleep 1
    s_branch L_lw_s3a
L_lwok_s3a:
    s_setprio 3
    s_lshl_b32 s65, s28, 9
    v_lshlrev_b32 v248, 3, v1
    v_add_u32 v252, s65, v248
    ds_read_b128 v[196:199], v2 offset:20992
    ds_read_b128 v[200:203], v2 offset:22016
    ds_read_b128 v[204:207], v2 offset:23040
    ds_read_b128 v[208:211], v2 offset:24064
    v_bfe_u32 v248, v1, 3, 1
    v_lshrrev_b32 v249, 4, v1
    v_lshlrev_b32 v251, 8, v248
    v_add_u32 v251, s65, v251
    v_lshl_add_u32 v253, v249, 4, v251
    s_waitcnt lgkmcnt(0)
    v_add_f32 v196, v196, v204
    v_add_f32 v197, v197, v205
    v_add_f32 v198, v198, v206
    v_add_f32 v199, v199, v207
    v_add_f32 v200, v200, v208
    v_add_f32 v201, v201, v209
    v_add_f32 v202, v202, v210
    v_add_f32 v203, v203, v211
    v_add_f32 v196, v196, v200
    v_add_f32 v197, v197, v201
    v_add_f32 v198, v198, v202
    v_add_f32 v199, v199, v203
    v_cvt_pk_bf16_f32 v200, v196, v197
    v_cvt_pk_bf16_f32 v201, v198, v199
    ds_write_b64 v252, v[200:201] offset:8704
    s_waitcnt lgkmcnt(0)
    ds_read_b128 v[16:19], v253 offset:8704
    ds_read_b128 v[20:23], v253 offset:8768
    ds_read_b128 v[24:27], v253 offset:8832
    ds_read_b128 v[28:31], v253 offset:8896
    s_waitcnt lgkmcnt(0)
    v_min_u32 v254, 17, v1
    v_lshlrev_b32 v254, 2, v254
    ds_read_b32 v208, v254 offset:2816
    ds_read_b32 v209, v254 offset:2888
    s_waitcnt lgkmcnt(0)
    v_cvt_pk_bf16_f32 v248, v208, v209
    v_lshlrev_b32 v208, 16, v248
    v_and_b32 v209, s75, v248
    v_mul_f32 v210, s71, v208
    v_exp_f32 v210, -v210
    s_nop 0
    v_add_f32 v210, 1.0, v210
    v_rcp_f32 v211, v210
    s_nop 0
    v_mul_f32 v212, v208, v211
    v_fma_f32 v213, -v212, v210, v208
    v_fma_f32 v213, v213, v211, v212
    v_cmp_u_f32 vcc, v213, v213
    s_nop 1
    v_cndmask_b32 v212, v213, v212, vcc
    v_cvt_pk_bf16_f32 v212, v212, v212
    v_and_b32 v212, s75, v212
    v_mul_f32 v212, v212, v209
    v_cvt_pk_bf16_f32 v212, v212, v212
    v_and_b32 v212, s75, v212
    s_lshl_b32 s66, s28, 7
    v_add_u32 v254, s66, v254
    ds_write_b32 v254, v212 offset:3072
    v_mul_u32_u24 v230, 24, v224
    v_add_u32 v227, s66, v230
    s_waitcnt lgkmcnt(0)
    ds_read_b32 v176, v227 offset:3072
    ds_read_b32 v177, v227 offset:3076
    ds_read_b32 v178, v227 offset:3080
    ds_read_b32 v179, v227 offset:3084
    ds_read_b32 v180, v227 offset:3088
    ds_read_b32 v181, v227 offset:3092
    v_and_b32 v248, 15, v1
    v_lshrrev_b32 v249, 4, v1
    v_lshlrev_b32 v250, 8, v248
    v_add_u32 v250, s95, v250
    v_add_u32 v251, 0, v249
    v_xor_b32 v251, v251, v248
    v_lshl_add_u32 v252, v251, 4, v250
    v_add_u32 v251, 4, v249
    v_xor_b32 v251, v251, v248
    v_lshl_add_u32 v253, v251, 4, v250
    v_add_u32 v251, 8, v249
    v_xor_b32 v251, v251, v248
    v_lshl_add_u32 v254, v251, 4, v250
    v_add_u32 v251, 12, v249
    v_xor_b32 v251, v251, v248
    v_lshl_add_u32 v255, v251, 4, v250
    s_waitcnt vmcnt(14)
    ds_read_b128 v[32:35], v252 offset:0
    ds_read_b128 v[36:39], v253 offset:0
    ds_read_b128 v[40:43], v254 offset:0
    ds_read_b128 v[44:47], v255 offset:0
    ds_read_b128 v[48:51], v252 offset:4096
    ds_read_b128 v[52:55], v253 offset:4096
    ds_read_b128 v[56:59], v254 offset:4096
    ds_read_b128 v[60:63], v255 offset:4096
    ds_read_b128 v[64:67], v252 offset:8192
    ds_read_b128 v[68:71], v253 offset:8192
    ds_read_b128 v[72:75], v254 offset:8192
    ds_read_b128 v[76:79], v255 offset:8192
    s_waitcnt lgkmcnt(0)
    v_mfma_f32_16x16x32_bf16 v[196:199], v[32:35], v[16:19], 0
    v_mfma_f32_16x16x32_bf16 v[200:203], v[48:51], v[16:19], 0
    v_mfma_f32_16x16x32_bf16 v[204:207], v[64:67], v[16:19], 0
    v_mfma_f32_16x16x32_bf16 v[196:199], v[36:39], v[20:23], v[196:199]
    v_mfma_f32_16x16x32_bf16 v[200:203], v[52:55], v[20:23], v[200:203]
    v_mfma_f32_16x16x32_bf16 v[204:207], v[68:71], v[20:23], v[204:207]
    v_mfma_f32_16x16x32_bf16 v[196:199], v[40:43], v[24:27], v[196:199]
    v_mfma_f32_16x16x32_bf16 v[200:203], v[56:59], v[24:27], v[200:203]
    v_mfma_f32_16x16x32_bf16 v[204:207], v[72:75], v[24:27], v[204:207]
    v_mfma_f32_16x16x32_bf16 v[196:199], v[44:47], v[28:31], v[196:199]
    v_mfma_f32_16x16x32_bf16 v[200:203], v[60:63], v[28:31], v[200:203]
    v_mfma_f32_16x16x32_bf16 v[204:207], v[76:79], v[28:31], v[204:207]
    s_nop 5
    v_cvt_pk_bf16_f32 v208, v196, v197
    v_cvt_pk_bf16_f32 v209, v198, v199
    v_cvt_pk_bf16_f32 v210, v200, v201
    v_cvt_pk_bf16_f32 v211, v202, v203
    v_cvt_pk_bf16_f32 v212, v204, v205
    v_cvt_pk_bf16_f32 v213, v206, v207
    v_lshlrev_b32 v196, 16, v208
    v_and_b32 v197, s75, v208
    v_lshlrev_b32 v198, 16, v209
    v_and_b32 v199, s75, v209
    v_lshlrev_b32 v200, 16, v210
    v_and_b32 v201, s75, v210
    v_lshlrev_b32 v202, 16, v211
    v_and_b32 v203, s75, v211
    v_lshlrev_b32 v204, 16, v212
    v_and_b32 v205, s75, v212
    v_lshlrev_b32 v206, 16, v213
    v_and_b32 v207, s75, v213
    v_mul_f32 v196, s70, v196
    v_mul_f32 v197, s70, v197
    v_mul_f32 v198, s70, v198
    v_mul_f32 v199, s70, v199
    v_mul_f32 v200, s70, v200
    v_mul_f32 v201, s70, v201
    v_mul_f32 v202, s70, v202
    v_mul_f32 v203, s70, v203
    v_mul_f32 v204, s70, v204
    v_mul_f32 v205, s70, v205
    v_mul_f32 v206, s70, v206
    v_mul_f32 v207, s70, v207
    v_cvt_pk_bf16_f32 v208, v196, v197
    v_cvt_pk_bf16_f32 v209, v198, v199
    v_cvt_pk_bf16_f32 v210, v200, v201
    v_cvt_pk_bf16_f32 v211, v202, v203
    v_cvt_pk_bf16_f32 v212, v204, v205
    v_cvt_pk_bf16_f32 v213, v206, v207
    v_lshlrev_b32 v196, 16, v208
    v_and_b32 v197, s75, v208
    v_lshlrev_b32 v198, 16, v209
    v_and_b32 v199, s75, v209
    v_lshlrev_b32 v200, 16, v210
    v_and_b32 v201, s75, v210
    v_lshlrev_b32 v202, 16, v211
    v_and_b32 v203, s75, v211
    v_lshlrev_b32 v204, 16, v212
    v_and_b32 v205, s75, v212
    v_lshlrev_b32 v206, 16, v213
    v_and_b32 v207, s75, v213
    v_max3_f32 v208, v196, v197, v198
    v_max3_f32 v209, v199, v200, v201
    v_max3_f32 v210, v202, v203, v204
    v_max3_f32 v211, v205, v206, v207
    v_max3_f32 v212, v208, v209, v210
    v_max_f32 v213, v212, v211
    v_mov_b32 v218, v213
    v_mov_b32 v208, v218
    s_nop 1
    v_permlane16_swap_b32 v218, v208
    v_max_f32 v218, v218, v208
    v_mov_b32 v208, v218
    s_nop 1
    v_permlane32_swap_b32 v218, v208
    v_max_f32 v218, v218, v208
    v_sub_f32 v196, v196, v218
    v_sub_f32 v197, v197, v218
    v_sub_f32 v198, v198, v218
    v_sub_f32 v199, v199, v218
    v_sub_f32 v200, v200, v218
    v_sub_f32 v201, v201, v218
    v_sub_f32 v202, v202, v218
    v_sub_f32 v203, v203, v218
    v_sub_f32 v204, v204, v218
    v_sub_f32 v205, v205, v218
    v_sub_f32 v206, v206, v218
    v_sub_f32 v207, v207, v218
    v_mul_f32 v196, s71, v196
    v_mul_f32 v197, s71, v197
    v_mul_f32 v198, s71, v198
    v_mul_f32 v199, s71, v199
    v_mul_f32 v200, s71, v200
    v_mul_f32 v201, s71, v201
    v_mul_f32 v202, s71, v202
    v_mul_f32 v203, s71, v203
    v_mul_f32 v204, s71, v204
    v_mul_f32 v205, s71, v205
    v_mul_f32 v206, s71, v206
    v_mul_f32 v207, s71, v207
    v_exp_f32 v196, v196
    v_exp_f32 v197, v197
    v_exp_f32 v198, v198
    v_exp_f32 v199, v199
    v_exp_f32 v200, v200
    v_exp_f32 v201, v201
    v_exp_f32 v202, v202
    v_exp_f32 v203, v203
    v_exp_f32 v204, v204
    v_exp_f32 v205, v205
    v_exp_f32 v206, v206
    v_exp_f32 v207, v207
    v_add_f32 v208, v196, v197
    v_add_f32 v209, v198, v199
    v_add_f32 v210, v200, v201
    v_add_f32 v211, v202, v203
    v_add_f32 v212, v204, v205
    v_add_f32 v213, v206, v207
    v_add_f32 v208, v208, v213
    v_add_f32 v209, v209, v212
    v_add_f32 v210, v210, v211
    v_add_f32 v208, v208, v210
    v_add_f32 v208, v208, v209
    v_mov_b32 v219, v208
    v_mov_b32 v208, v219
    s_nop 1
    v_permlane16_swap_b32 v219, v208
    v_add_f32 v219, v219, v208
    v_mov_b32 v208, v219
    s_nop 1
    v_permlane32_swap_b32 v219, v208
    v_add_f32 v219, v219, v208
    v_cvt_pk_bf16_f32 v196, v196, v196
    v_cvt_pk_bf16_f32 v197, v197, v197
    v_cvt_pk_bf16_f32 v198, v198, v198
    v_cvt_pk_bf16_f32 v199, v199, v199
    v_cvt_pk_bf16_f32 v200, v200, v200
    v_cvt_pk_bf16_f32 v201, v201, v201
    v_cvt_pk_bf16_f32 v202, v202, v202
    v_cvt_pk_bf16_f32 v203, v203, v203
    v_cvt_pk_bf16_f32 v204, v204, v204
    v_cvt_pk_bf16_f32 v205, v205, v205
    v_cvt_pk_bf16_f32 v206, v206, v206
    v_cvt_pk_bf16_f32 v207, v207, v207
    v_and_b32 v32, v196, v8
    v_and_b32 v33, v196, v9
    v_and_b32 v34, v196, v10
    v_and_b32 v35, v196, v11
    v_and_b32 v36, v197, v8
    v_and_b32 v37, v197, v9
    v_and_b32 v38, v197, v10
    v_and_b32 v39, v197, v11
    v_and_b32 v40, v198, v8
    v_and_b32 v41, v198, v9
    v_and_b32 v42, v198, v10
    v_and_b32 v43, v198, v11
    v_and_b32 v44, v199, v8
    v_and_b32 v45, v199, v9
    v_and_b32 v46, v199, v10
    v_and_b32 v47, v199, v11
    v_and_b32 v48, v200, v8
    v_and_b32 v49, v200, v9
    v_and_b32 v50, v200, v10
    v_and_b32 v51, v200, v11
    v_and_b32 v52, v201, v8
    v_and_b32 v53, v201, v9
    v_and_b32 v54, v201, v10
    v_and_b32 v55, v201, v11
    v_and_b32 v56, v202, v8
    v_and_b32 v57, v202, v9
    v_and_b32 v58, v202, v10
    v_and_b32 v59, v202, v11
    v_and_b32 v60, v203, v8
    v_and_b32 v61, v203, v9
    v_and_b32 v62, v203, v10
    v_and_b32 v63, v203, v11
    v_and_b32 v64, v204, v8
    v_and_b32 v65, v204, v9
    v_and_b32 v66, v204, v10
    v_and_b32 v67, v204, v11
    v_and_b32 v68, v205, v8
    v_and_b32 v69, v205, v9
    v_and_b32 v70, v205, v10
    v_and_b32 v71, v205, v11
    v_and_b32 v72, v206, v8
    v_and_b32 v73, v206, v9
    v_and_b32 v74, v206, v10
    v_and_b32 v75, v206, v11
    v_and_b32 v76, v207, v8
    v_and_b32 v77, v207, v9
    v_and_b32 v78, v207, v10
    v_and_b32 v79, v207, v11
    s_setprio 0
    s_waitcnt vmcnt(13)
    v_mfma_f32_16x16x32_bf16 v[12:15], v[80:83], v[32:35], 0
    buffer_load_dwordx4 v[128:131], v225, s[52:55], s77 offen offset:0 nt
    s_waitcnt vmcnt(13)
    v_mfma_f32_16x16x32_bf16 v[12:15], v[84:87], v[36:39], v[12:15]
    buffer_load_dwordx4 v[132:135], v225, s[52:55], s77 offen offset:1152 nt
    s_waitcnt vmcnt(13)
    v_mfma_f32_16x16x32_bf16 v[12:15], v[88:91], v[40:43], v[12:15]
    buffer_load_dwordx4 v[136:139], v225, s[52:55], s77 offen offset:2304 nt
    s_waitcnt vmcnt(13)
    v_mfma_f32_16x16x32_bf16 v[12:15], v[92:95], v[44:47], v[12:15]
    s_add_u32 s67, s77, 3456
    buffer_load_dwordx4 v[140:143], v225, s[52:55], s67 offen offset:0 nt
    s_waitcnt vmcnt(13)
    v_mfma_f32_16x16x32_bf16 v[12:15], v[96:99], v[48:51], v[12:15]
    buffer_load_dwordx4 v[144:147], v225, s[52:55], s67 offen offset:1152 nt
    s_waitcnt vmcnt(13)
    v_mfma_f32_16x16x32_bf16 v[12:15], v[100:103], v[52:55], v[12:15]
    buffer_load_dwordx4 v[148:151], v225, s[52:55], s67 offen offset:2304 nt
    s_waitcnt vmcnt(13)
    v_mfma_f32_16x16x32_bf16 v[12:15], v[104:107], v[56:59], v[12:15]
    buffer_load_dwordx4 v[152:155], v225, s[96:99], s76 offen offset:0 nt
    s_waitcnt vmcnt(13)
    v_mfma_f32_16x16x32_bf16 v[12:15], v[108:111], v[60:63], v[12:15]
    buffer_load_dwordx4 v[156:159], v225, s[96:99], s76 offen offset:1152 nt
    s_waitcnt vmcnt(13)
    v_mfma_f32_16x16x32_bf16 v[12:15], v[112:115], v[64:67], v[12:15]
    buffer_load_dwordx4 v[160:163], v225, s[96:99], s76 offen offset:2304 nt
    s_waitcnt vmcnt(13)
    v_mfma_f32_16x16x32_bf16 v[12:15], v[116:119], v[68:71], v[12:15]
    s_add_u32 s67, s76, 3456
    buffer_load_dwordx4 v[164:167], v225, s[96:99], s67 offen offset:0 nt
    s_waitcnt vmcnt(13)
    v_mfma_f32_16x16x32_bf16 v[12:15], v[120:123], v[72:75], v[12:15]
    buffer_load_dwordx4 v[168:171], v225, s[96:99], s67 offen offset:1152 nt
    s_waitcnt vmcnt(13)
    v_mfma_f32_16x16x32_bf16 v[12:15], v[124:127], v[76:79], v[12:15]
    buffer_load_dwordx4 v[172:175], v225, s[96:99], s67 offen offset:2304 nt
    s_setprio 3
    s_lshl_b32 s65, s28, 10
    v_add_u32 v248, s65, v2
    s_lshl_b32 s65, s28, 4
    v_and_b32 v249, 8, v1
    v_add_u32 v249, s65, v249
    s_nop 0
    ds_write_b128 v248, v[12:15] offset:12800
    s_mov_b64 exec, 0x101
    ds_write_b64 v249, v[218:219] offset:2624
    s_mov_b64 exec, -1
    s_waitcnt lgkmcnt(0)
    s_barrier
    s_cmp_ge_u32 s28, 2
    s_cbranch_scc1 L_skipcomb
    v_lshrrev_b32 v248, 4, v1
    v_and_b32 v249, 3, v1
    v_lshlrev_b32 v248, 8, v248
    v_lshl_add_u32 v248, v249, 5, v248
    v_bfe_u32 v249, v1, 2, 2
    v_lshl_add_u32 v248, v249, 2, v248
    s_lshl_b32 s65, s28, 7
    s_add_u32 s65, s65, 12800
    v_add_u32 v248, s65, v248
    v_add_u32 v249, 16, v248
    s_lshl_b32 s65, s28, 3
    s_add_u32 s65, s65, 2624
    v_mov_b32 v250, s65
    ds_read2_b64 v[32:35], v250 offset0:0 offset1:2
    ds_read2_b64 v[36:39], v250 offset0:4 offset1:6
    ds_read2_b64 v[40:43], v250 offset0:8 offset1:10
    ds_read2_b64 v[44:47], v250 offset0:12 offset1:14
    ds_read2st64_b32 v[48:49], v248 offset0:0 offset1:4
    ds_read2st64_b32 v[50:51], v248 offset0:8 offset1:12
    ds_read2st64_b32 v[52:53], v248 offset0:16 offset1:20
    ds_read2st64_b32 v[54:55], v248 offset0:24 offset1:28
    ds_read2st64_b32 v[56:57], v249 offset0:0 offset1:4
    ds_read2st64_b32 v[58:59], v249 offset0:8 offset1:12
    ds_read2st64_b32 v[60:61], v249 offset0:16 offset1:20
    ds_read2st64_b32 v[62:63], v249 offset0:24 offset1:28
    s_lshl_b32 s65, s29, 16
    s_lshl_b32 s66, s30, 8
    s_add_u32 s65, s65, s66
    s_add_u32 s65, s65, 4096
    s_lshl_b32 s66, s28, 15
    s_add_u32 s66, s65, s66
    v_lshrrev_b32 v251, 3, v1
    v_and_b32 v252, 7, v1
    v_lshlrev_b32 v252, 4, v252
    v_lshl_add_u32 v251, v251, 12, v252
    v_lshlrev_b32 v252, 12, v1
    s_waitcnt lgkmcnt(0)
    v_max3_f32 v64, v32, v34, v36
    v_max3_f32 v65, v38, v40, v42
    v_max3_f32 v64, v64, v44, v46
    v_max_f32 v64, v64, v65
    v_sub_f32 v32, v32, v64
    v_sub_f32 v34, v34, v64
    v_sub_f32 v36, v36, v64
    v_sub_f32 v38, v38, v64
    v_sub_f32 v40, v40, v64
    v_sub_f32 v42, v42, v64
    v_sub_f32 v44, v44, v64
    v_sub_f32 v46, v46, v64
    v_mul_f32 v32, s71, v32
    v_mul_f32 v34, s71, v34
    v_mul_f32 v36, s71, v36
    v_mul_f32 v38, s71, v38
    v_mul_f32 v40, s71, v40
    v_mul_f32 v42, s71, v42
    v_mul_f32 v44, s71, v44
    v_mul_f32 v46, s71, v46
    v_exp_f32 v32, v32
    v_exp_f32 v34, v34
    v_exp_f32 v36, v36
    v_exp_f32 v38, v38
    v_exp_f32 v40, v40
    v_exp_f32 v42, v42
    v_exp_f32 v44, v44
    v_exp_f32 v46, v46
    v_mul_f32 v68, v32, v48
    v_mul_f32 v70, v32, v56
    v_mul_f32 v74, v32, v33
    v_fmac_f32 v68, v34, v49
    v_fmac_f32 v70, v34, v57
    v_fmac_f32 v74, v34, v35
    v_fmac_f32 v68, v36, v50
    v_fmac_f32 v70, v36, v58
    v_fmac_f32 v74, v36, v37
    v_fmac_f32 v68, v38, v51
    v_fmac_f32 v70, v38, v59
    v_fmac_f32 v74, v38, v39
    v_fmac_f32 v68, v40, v52
    v_fmac_f32 v70, v40, v60
    v_fmac_f32 v74, v40, v41
    v_fmac_f32 v68, v42, v53
    v_fmac_f32 v70, v42, v61
    v_fmac_f32 v74, v42, v43
    v_fmac_f32 v68, v44, v54
    v_fmac_f32 v70, v44, v62
    v_fmac_f32 v74, v44, v45
    v_fmac_f32 v68, v46, v55
    v_fmac_f32 v70, v46, v63
    v_fmac_f32 v74, v46, v47
    v_mov_b32 v69, s31
    v_mov_b32 v71, s31
    v_mov_b32 v72, v64
    v_mov_b32 v73, s31
    v_mov_b32 v75, s31
    s_add_u32 s67, s66, 8388608
    buffer_store_dwordx4 v[68:71], v251, s[48:51], s67 offen
    s_mov_b64 exec, 0xff
    buffer_store_dwordx4 v[72:75], v252, s[48:51], s67 offen offset:128
    s_mov_b64 exec, -1
    buffer_store_dwordx4 v[68:71], v251, s[48:51], s66 offen sc1
    s_mov_b64 exec, 0xff
    buffer_store_dwordx4 v[72:75], v252, s[48:51], s66 offen offset:128 sc1
    s_mov_b64 exec, -1
L_skipcomb:
    s_nop 7
    s_nop 1
    s_waitcnt vmcnt(11)
    v_lshlrev_b32 v248, 16, v128
    v_and_b32 v249, s75, v128
    v_lshlrev_b32 v250, 16, v129
    v_and_b32 v251, s75, v129
    v_lshlrev_b32 v252, 16, v130
    v_and_b32 v253, s75, v130
    v_lshlrev_b32 v254, 16, v131
    v_and_b32 v255, s75, v131
    v_mul_f32 v240, v248, v176
    v_mul_f32 v241, v249, v176
    v_mul_f32 v242, v250, v176
    v_mul_f32 v243, v251, v176
    v_mul_f32 v244, v252, v176
    v_mul_f32 v245, v253, v176
    v_mul_f32 v246, v254, v176
    v_mul_f32 v247, v255, v176
    s_waitcnt vmcnt(10)
    v_lshlrev_b32 v248, 16, v132
    v_and_b32 v249, s75, v132
    v_lshlrev_b32 v250, 16, v133
    v_and_b32 v251, s75, v133
    v_lshlrev_b32 v252, 16, v134
    v_and_b32 v253, s75, v134
    v_lshlrev_b32 v254, 16, v135
    v_and_b32 v255, s75, v135
    v_fmac_f32 v240, v248, v177
    v_fmac_f32 v241, v249, v177
    v_fmac_f32 v242, v250, v177
    v_fmac_f32 v243, v251, v177
    v_fmac_f32 v244, v252, v177
    v_fmac_f32 v245, v253, v177
    v_fmac_f32 v246, v254, v177
    v_fmac_f32 v247, v255, v177
    s_waitcnt vmcnt(9)
    v_lshlrev_b32 v248, 16, v136
    v_and_b32 v249, s75, v136
    v_lshlrev_b32 v250, 16, v137
    v_and_b32 v251, s75, v137
    v_lshlrev_b32 v252, 16, v138
    v_and_b32 v253, s75, v138
    v_lshlrev_b32 v254, 16, v139
    v_and_b32 v255, s75, v139
    v_fmac_f32 v240, v248, v178
    v_fmac_f32 v241, v249, v178
    v_fmac_f32 v242, v250, v178
    v_fmac_f32 v243, v251, v178
    v_fmac_f32 v244, v252, v178
    v_fmac_f32 v245, v253, v178
    v_fmac_f32 v246, v254, v178
    v_fmac_f32 v247, v255, v178
    s_waitcnt vmcnt(8)
    v_lshlrev_b32 v248, 16, v140
    v_and_b32 v249, s75, v140
    v_lshlrev_b32 v250, 16, v141
    v_and_b32 v251, s75, v141
    v_lshlrev_b32 v252, 16, v142
    v_and_b32 v253, s75, v142
    v_lshlrev_b32 v254, 16, v143
    v_and_b32 v255, s75, v143
    v_fmac_f32 v240, v248, v179
    v_fmac_f32 v241, v249, v179
    v_fmac_f32 v242, v250, v179
    v_fmac_f32 v243, v251, v179
    v_fmac_f32 v244, v252, v179
    v_fmac_f32 v245, v253, v179
    v_fmac_f32 v246, v254, v179
    v_fmac_f32 v247, v255, v179
    s_waitcnt vmcnt(7)
    v_lshlrev_b32 v248, 16, v144
    v_and_b32 v249, s75, v144
    v_lshlrev_b32 v250, 16, v145
    v_and_b32 v251, s75, v145
    v_lshlrev_b32 v252, 16, v146
    v_and_b32 v253, s75, v146
    v_lshlrev_b32 v254, 16, v147
    v_and_b32 v255, s75, v147
    v_fmac_f32 v240, v248, v180
    v_fmac_f32 v241, v249, v180
    v_fmac_f32 v242, v250, v180
    v_fmac_f32 v243, v251, v180
    v_fmac_f32 v244, v252, v180
    v_fmac_f32 v245, v253, v180
    v_fmac_f32 v246, v254, v180
    v_fmac_f32 v247, v255, v180
    s_waitcnt vmcnt(6)
    v_lshlrev_b32 v248, 16, v148
    v_and_b32 v249, s75, v148
    v_lshlrev_b32 v250, 16, v149
    v_and_b32 v251, s75, v149
    v_lshlrev_b32 v252, 16, v150
    v_and_b32 v253, s75, v150
    v_lshlrev_b32 v254, 16, v151
    v_and_b32 v255, s75, v151
    v_fmac_f32 v240, v248, v181
    v_fmac_f32 v241, v249, v181
    v_fmac_f32 v242, v250, v181
    v_fmac_f32 v243, v251, v181
    v_fmac_f32 v244, v252, v181
    v_fmac_f32 v245, v253, v181
    v_fmac_f32 v246, v254, v181
    v_fmac_f32 v247, v255, v181
    v_lshlrev_b32 v249, 5, v0
    s_mov_b64 exec, s[80:81]
    ds_write_b128 v249, v[240:243] offset:39680
    ds_write_b128 v249, v[244:247] offset:39696
    s_mov_b64 exec, -1
    s_waitcnt lgkmcnt(0)
    v_mov_b32 v254, 1
    v_mov_b32 v255, 2568
    s_mov_b64 exec, 1
    ds_add_u32 v255, v254
    s_mov_b64 exec, -1
    s_barrier
    ds_read_b32 v80, v230 offset:3584
    ds_read_b32 v81, v230 offset:3588
    ds_read_b32 v82, v230 offset:3592
    ds_read_b32 v83, v230 offset:3596
    ds_read_b32 v84, v230 offset:3600
    ds_read_b32 v85, v230 offset:3604
    s_waitcnt vmcnt(0)
    s_waitcnt lgkmcnt(0)
    v_lshlrev_b32 v248, 16, v152
    v_and_b32 v249, s75, v152
    v_lshlrev_b32 v250, 16, v153
    v_and_b32 v251, s75, v153
    v_lshlrev_b32 v252, 16, v154
    v_and_b32 v253, s75, v154
    v_lshlrev_b32 v254, 16, v155
    v_and_b32 v255, s75, v155
    v_mul_f32 v232, v248, v80
    v_mul_f32 v233, v249, v80
    v_mul_f32 v234, v250, v80
    v_mul_f32 v235, v251, v80
    v_mul_f32 v236, v252, v80
    v_mul_f32 v237, v253, v80
    v_mul_f32 v238, v254, v80
    v_mul_f32 v239, v255, v80
    v_lshlrev_b32 v248, 16, v156
    v_and_b32 v249, s75, v156
    v_lshlrev_b32 v250, 16, v157
    v_and_b32 v251, s75, v157
    v_lshlrev_b32 v252, 16, v158
    v_and_b32 v253, s75, v158
    v_lshlrev_b32 v254, 16, v159
    v_and_b32 v255, s75, v159
    v_fmac_f32 v232, v248, v81
    v_fmac_f32 v233, v249, v81
    v_fmac_f32 v234, v250, v81
    v_fmac_f32 v235, v251, v81
    v_fmac_f32 v236, v252, v81
    v_fmac_f32 v237, v253, v81
    v_fmac_f32 v238, v254, v81
    v_fmac_f32 v239, v255, v81
    v_lshlrev_b32 v248, 16, v160
    v_and_b32 v249, s75, v160
    v_lshlrev_b32 v250, 16, v161
    v_and_b32 v251, s75, v161
    v_lshlrev_b32 v252, 16, v162
    v_and_b32 v253, s75, v162
    v_lshlrev_b32 v254, 16, v163
    v_and_b32 v255, s75, v163
    v_fmac_f32 v232, v248, v82
    v_fmac_f32 v233, v249, v82
    v_fmac_f32 v234, v250, v82
    v_fmac_f32 v235, v251, v82
    v_fmac_f32 v236, v252, v82
    v_fmac_f32 v237, v253, v82
    v_fmac_f32 v238, v254, v82
    v_fmac_f32 v239, v255, v82
    v_lshlrev_b32 v248, 16, v164
    v_and_b32 v249, s75, v164
    v_lshlrev_b32 v250, 16, v165
    v_and_b32 v251, s75, v165
    v_lshlrev_b32 v252, 16, v166
    v_and_b32 v253, s75, v166
    v_lshlrev_b32 v254, 16, v167
    v_and_b32 v255, s75, v167
    v_fmac_f32 v232, v248, v83
    v_fmac_f32 v233, v249, v83
    v_fmac_f32 v234, v250, v83
    v_fmac_f32 v235, v251, v83
    v_fmac_f32 v236, v252, v83
    v_fmac_f32 v237, v253, v83
    v_fmac_f32 v238, v254, v83
    v_fmac_f32 v239, v255, v83
    v_lshlrev_b32 v248, 16, v168
    v_and_b32 v249, s75, v168
    v_lshlrev_b32 v250, 16, v169
    v_and_b32 v251, s75, v169
    v_lshlrev_b32 v252, 16, v170
    v_and_b32 v253, s75, v170
    v_lshlrev_b32 v254, 16, v171
    v_and_b32 v255, s75, v171
    v_fmac_f32 v232, v248, v84
    v_fmac_f32 v233, v249, v84
    v_fmac_f32 v234, v250, v84
    v_fmac_f32 v235, v251, v84
    v_fmac_f32 v236, v252, v84
    v_fmac_f32 v237, v253, v84
    v_fmac_f32 v238, v254, v84
    v_fmac_f32 v239, v255, v84
    v_lshlrev_b32 v248, 16, v172
    v_and_b32 v249, s75, v172
    v_lshlrev_b32 v250, 16, v173
    v_and_b32 v251, s75, v173
    v_lshlrev_b32 v252, 16, v174
    v_and_b32 v253, s75, v174
    v_lshlrev_b32 v254, 16, v175
    v_and_b32 v255, s75, v175
    v_fmac_f32 v232, v248, v85
    v_fmac_f32 v233, v249, v85
    v_fmac_f32 v234, v250, v85
    v_fmac_f32 v235, v251, v85
    v_fmac_f32 v236, v252, v85
    v_fmac_f32 v237, v253, v85
    v_fmac_f32 v238, v254, v85
    v_fmac_f32 v239, v255, v85
    v_lshlrev_b32 v249, 5, v0
    s_mov_b64 exec, s[80:81]
    ds_write_b128 v249, v[232:235] offset:32768
    ds_write_b128 v249, v[236:239] offset:32784
    s_mov_b64 exec, -1
    s_waitcnt lgkmcnt(0)
    s_barrier
    v_subrev_u32 v252, 0, v0
    v_min_u32 v248, 287, v252
    v_lshlrev_b32 v248, 3, v248
    ds_read_b64 v[32:33], v248 offset:32768
    ds_read_b64 v[34:35], v248 offset:35072
    ds_read_b64 v[36:37], v248 offset:37376
    v_lshrrev_b32 v250, 2, v252
    v_and_b32 v251, 3, v252
    v_lshlrev_b32 v251, 4, v251
    v_lshl_add_u32 v250, v250, 15, v251
    v_mov_b32 v251, 0x80000000
    v_cmp_gt_u32 vcc, 288, v252
    s_nop 1
    v_cndmask_b32 v250, v251, v250, vcc
    s_lshl_b32 s65, s2, 6
    s_add_u32 s65, s65, 4194304
    s_waitcnt lgkmcnt(0)
    v_add_f32 v32, v32, v34
    v_add_f32 v40, v32, v36
    v_add_f32 v33, v33, v35
    v_add_f32 v42, v33, v37
    v_mov_b32 v41, s31
    v_mov_b32 v43, s31
    buffer_store_dwordx4 v[40:43], v250, s[48:51], s65 offen sc1
    s_branch L_tail
L_B:
    s_nop 7
    s_nop 1
    s_setprio 2
    v_lshrrev_b32 v248, 4, v1
    v_and_b32 v249, 15, v1
    v_lshlrev_b32 v250, 8, v248
    v_add_u32 v251, 0, v248
    v_xor_b32 v251, v251, v249
    v_lshl_add_u32 v220, v251, 4, v250
    v_add_u32 v251, 4, v248
    v_xor_b32 v251, v251, v249
    v_lshl_add_u32 v221, v251, 4, v250
    v_add_u32 v251, 8, v248
    v_xor_b32 v251, v251, v249
    v_lshl_add_u32 v222, v251, 4, v250
    v_add_u32 v251, 12, v248
    v_xor_b32 v251, v251, v249
    v_lshl_add_u32 v223, v251, 4, v250
    s_add_u32 m0, s95, 0
    s_nop 0
    buffer_load_dwordx4 v220, s[36:39], s60 offen offset:0 nt lds
    buffer_load_dwordx4 v221, s[36:39], s60 offen offset:1024 nt lds
    buffer_load_dwordx4 v222, s[36:39], s60 offen offset:2048 nt lds
    buffer_load_dwordx4 v223, s[36:39], s60 offen offset:3072 nt lds
    s_add_u32 m0, s95, 4096
    s_nop 0
    buffer_load_dwordx4 v220, s[36:39], s61 offen offset:0 nt lds
    buffer_load_dwordx4 v221, s[36:39], s61 offen offset:1024 nt lds
    buffer_load_dwordx4 v222, s[36:39], s61 offen offset:2048 nt lds
    buffer_load_dwordx4 v223, s[36:39], s61 offen offset:3072 nt lds
    s_add_u32 m0, s95, 8192
    s_nop 0
    buffer_load_dwordx4 v220, s[36:39], s62 offen offset:0 nt lds
    buffer_load_dwordx4 v221, s[36:39], s62 offen offset:1024 nt lds
    buffer_load_dwordx4 v222, s[36:39], s62 offen offset:2048 nt lds
    buffer_load_dwordx4 v223, s[36:39], s62 offen offset:3072 nt lds
    s_add_u32 m0, s95, 12288
    s_nop 0
    buffer_load_dwordx4 v220, s[36:39], s63 offen offset:0 nt lds
    buffer_load_dwordx4 v221, s[36:39], s63 offen offset:1024 nt lds
    buffer_load_dwordx4 v222, s[36:39], s63 offen offset:2048 nt lds
    buffer_load_dwordx4 v223, s[36:39], s63 offen offset:3072 nt lds
    s_add_u32 m0, s95, 16384
    s_nop 0
    buffer_load_dwordx4 v220, s[36:39], s64 offen offset:0 nt lds
    buffer_load_dwordx4 v221, s[36:39], s64 offen offset:1024 nt lds
    buffer_load_dwordx4 v222, s[36:39], s64 offen offset:2048 nt lds
    buffer_load_dwordx4 v223, s[36:39], s64 offen offset:3072 nt lds
    buffer_load_dwordx4 v[112:115], v4, s[40:43], s60 offen offset:0 nt
    buffer_load_dwordx4 v[116:119], v4, s[40:43], s60 offen offset:256 nt
    buffer_load_dwordx4 v[120:123], v4, s[40:43], s60 offen offset:512 nt
    buffer_load_dwordx4 v[124:127], v4, s[40:43], s60 offen offset:768 nt
    buffer_load_dwordx4 v[128:131], v4, s[40:43], s61 offen offset:0 nt
    buffer_load_dwordx4 v[132:135], v4, s[40:43], s61 offen offset:256 nt
    buffer_load_dwordx4 v[136:139], v4, s[40:43], s61 offen offset:512 nt
    buffer_load_dwordx4 v[140:143], v4, s[40:43], s61 offen offset:768 nt
    buffer_load_dwordx4 v[144:147], v4, s[40:43], s62 offen offset:0 nt
    buffer_load_dwordx4 v[148:151], v4, s[40:43], s62 offen offset:256 nt
    buffer_load_dwordx4 v[152:155], v4, s[40:43], s62 offen offset:512 nt
    buffer_load_dwordx4 v[156:159], v4, s[40:43], s62 offen offset:768 nt
    s_sub_u32 s65, s28, 4
    s_lshl_b32 s83, s65, 15
    s_add_u32 s83, s83, s82
    s_add_u32 s94, s83, 16384
    v_lshrrev_b32 v248, 5, v1
    v_and_b32 v249, 31, v1
    v_lshlrev_b32 v249, 4, v249
    v_lshl_add_u32 v5, v248, 13, v249
    v_lshrrev_b32 v248, 4, v1
    s_lshl_b32 s66, s65, 2
    v_add_u32 v249, s66, v248
    v_add_u32 v250, 135, v249
    v_cmp_le_u32 vcc, 9, v249
    s_nop 1
    v_cndmask_b32 v249, v249, v250, vcc
    v_and_b32 v250, 15, v1
    v_lshlrev_b32 v250, 13, v250
    v_lshl_add_u32 v227, v249, 4, v250
    v_and_b32 v248, 1, v248
    v_add_u32 v248, 151, v248
    v_lshl_add_u32 v230, v248, 4, v250
    s_mul_i32 s69, s30, 144
    s_add_u32 s69, s69, 2048
    s_add_u32 s69, s69, s82
    s_waitcnt lgkmcnt(0)
    s_add_u32 s31, s31, 1
    s_add_u32 s83, s83, 8388608
    s_add_u32 s94, s94, 8388608
    s_add_u32 s69, s69, 8388608
    v_mov_b32 v255, 2560
L_lw_s2c:
    ds_read_b32 v254, v255
    s_waitcnt lgkmcnt(0)
    v_readfirstlane_b32 s68, v254
    s_cmp_ge_u32 s68, 4
    s_cbranch_scc1 L_lwok_s2c
    s_sleep 1
    s_branch L_lw_s2c
L_lwok_s2c:
    buffer_load_dwordx4 v[192:195], v5, s[48:51], s83 offen sc1
    buffer_load_dwordx4 v[196:199], v5, s[48:51], s94 offen sc1
    buffer_load_dwordx4 v[200:203], v227, s[48:51], s69 offen sc1
    buffer_load_dwordx4 v[204:207], v230, s[48:51], s69 offen sc1
    buffer_load_dwordx4 v[160:163], v4, s[40:43], s63 offen offset:0 nt
    buffer_load_dwordx4 v[164:167], v4, s[40:43], s63 offen offset:256 nt
    buffer_load_dwordx4 v[168:171], v4, s[40:43], s63 offen offset:512 nt
    buffer_load_dwordx4 v[172:175], v4, s[40:43], s63 offen offset:768 nt
    buffer_load_dwordx4 v[176:179], v4, s[40:43], s64 offen offset:0 nt
    buffer_load_dwordx4 v[180:183], v4, s[40:43], s64 offen offset:256 nt
    buffer_load_dwordx4 v[184:187], v4, s[40:43], s64 offen offset:512 nt
    buffer_load_dwordx4 v[188:191], v4, s[40:43], s64 offen offset:768 nt
    s_waitcnt vmcnt(8)
    s_mov_b32 s74, 0x100000
L_h1chk:
    v_cmp_ne_u32 vcc, s31, v193
    v_cmp_ne_u32 s[78:79], s31, v195
    s_or_b64 vcc, vcc, s[78:79]
    v_cmp_ne_u32 s[78:79], s31, v197
    s_or_b64 vcc, vcc, s[78:79]
    v_cmp_ne_u32 s[78:79], s31, v199
    s_or_b64 vcc, vcc, s[78:79]
    v_cmp_ne_u32 s[78:79], s31, v201
    s_or_b64 vcc, vcc, s[78:79]
    v_cmp_ne_u32 s[78:79], s31, v203
    s_or_b64 vcc, vcc, s[78:79]
    v_cmp_ne_u32 s[78:79], s31, v205
    s_or_b64 vcc, vcc, s[78:79]
    v_cmp_ne_u32 s[78:79], s31, v207
    s_or_b64 vcc, vcc, s[78:79]
    s_cmp_eq_u64 vcc, 0
    s_cbranch_scc1 L_h1ok
    s_sub_u32 s74, s74, 1
    s_cmp_eq_u32 s74, 0
    s_cbranch_scc1 L_h1ok
    s_and_b32 s67, s74, 3
    s_cmp_eq_u32 s67, 0
    s_cselect_b32 s67, 0, 8388608
    s_andn2_b32 s83, s83, 8388608
    s_or_b32 s83, s83, s67
    s_andn2_b32 s94, s94, 8388608
    s_or_b32 s94, s94, s67
    s_andn2_b32 s69, s69, 8388608
    s_or_b32 s69, s69, s67
    buffer_load_dwordx4 v[192:195], v5, s[48:51], s83 offen sc1
    buffer_load_dwordx4 v[196:199], v5, s[48:51], s94 offen sc1
    buffer_load_dwordx4 v[200:203], v227, s[48:51], s69 offen sc1
    buffer_load_dwordx4 v[204:207], v230, s[48:51], s69 offen sc1
    s_waitcnt vmcnt(0)
    s_branch L_h1chk
L_h1ok:
    s_nop 7
    s_nop 1
    s_setprio 3
    v_mov_b32 v193, v194
    v_mov_b32 v197, v198
    v_mov_b32 v201, v202
    v_mov_b32 v205, v206
    v_add_f32 v200, v200, v200 row_ror:8
    v_add_f32 v201, v201, v201 row_ror:8
    v_add_f32 v204, v204, v204 row_ror:8
    v_add_f32 v205, v205, v205 row_ror:8
    v_add_f32 v200, v200, v200 row_ror:4
    v_add_f32 v201, v201, v201 row_ror:4
    v_add_f32 v204, v204, v204 row_ror:4
    v_add_f32 v205, v205, v205 row_ror:4
    v_add_f32 v200, v200, v200 row_ror:2
    v_add_f32 v201, v201, v201 row_ror:2
    v_add_f32 v204, v204, v204 row_ror:2
    v_add_f32 v205, v205, v205 row_ror:2
    v_add_f32 v200, v200, v200 row_ror:1
    v_add_f32 v201, v201, v201 row_ror:1
    v_add_f32 v204, v204, v204 row_ror:1
    v_add_f32 v205, v205, v205 row_ror:1
    s_lshl_b32 s66, s65, 10
    v_lshlrev_b32 v248, 3, v1
    v_add_u32 v252, s66, v248
    ds_write_b64 v252, v[192:193] offset:20992
    ds_write_b64 v252, v[196:197] offset:21504
    v_lshrrev_b32 v249, 4, v1
    s_lshl_b32 s66, s65, 5
    v_lshl_add_u32 v250, v249, 3, s66
    v_and_b32 v249, 1, v249
    v_lshlrev_b32 v249, 3, v249
    s_mov_b32 exec_lo, 0x00010001
    s_mov_b32 exec_hi, 0x00010001
    ds_write_b64 v250, v[200:201] offset:2816
    ds_write_b64 v249, v[204:205] offset:2944
    s_mov_b64 exec, -1
    s_waitcnt lgkmcnt(0)
    v_mov_b32 v254, 1
    v_mov_b32 v255, 2564
    s_mov_b64 exec, 1
    ds_add_u32 v255, v254
    s_mov_b64 exec, -1
    v_mov_b32 v255, 2564
L_lw_s3b:
    ds_read_b32 v254, v255
    s_waitcnt lgkmcnt(0)
    v_readfirstlane_b32 s68, v254
    s_cmp_ge_u32 s68, 4
    s_cbranch_scc1 L_lwok_s3b
    s_sleep 1
    s_branch L_lw_s3b
L_lwok_s3b:
    s_lshl_b32 s65, s28, 9
    v_lshlrev_b32 v248, 3, v1
    v_add_u32 v252, s65, v248
    ds_read_b128 v[192:195], v2 offset:20992
    ds_read_b128 v[196:199], v2 offset:22016
    ds_read_b128 v[200:203], v2 offset:23040
    ds_read_b128 v[204:207], v2 offset:24064
    v_bfe_u32 v248, v1, 3, 1
    v_lshrrev_b32 v249, 4, v1
    v_lshlrev_b32 v251, 8, v248
    v_add_u32 v251, s65, v251
    v_lshl_add_u32 v253, v249, 4, v251
    s_waitcnt lgkmcnt(0)
    v_add_f32 v192, v192, v200
    v_add_f32 v193, v193, v201
    v_add_f32 v194, v194, v202
    v_add_f32 v195, v195, v203
    v_add_f32 v196, v196, v204
    v_add_f32 v197, v197, v205
    v_add_f32 v198, v198, v206
    v_add_f32 v199, v199, v207
    v_add_f32 v192, v192, v196
    v_add_f32 v193, v193, v197
    v_add_f32 v194, v194, v198
    v_add_f32 v195, v195, v199
    v_cvt_pk_bf16_f32 v196, v192, v193
    v_cvt_pk_bf16_f32 v197, v194, v195
    ds_write_b64 v252, v[196:197] offset:8704
    s_waitcnt lgkmcnt(0)
    ds_read_b128 v[16:19], v253 offset:8704
    ds_read_b128 v[20:23], v253 offset:8768
    ds_read_b128 v[24:27], v253 offset:8832
    ds_read_b128 v[28:31], v253 offset:8896
    s_waitcnt lgkmcnt(0)
    v_and_b32 v248, 15, v1
    v_lshrrev_b32 v249, 4, v1
    v_lshlrev_b32 v250, 8, v248
    v_add_u32 v250, s95, v250
    v_add_u32 v251, 0, v249
    v_xor_b32 v251, v251, v248
    v_lshl_add_u32 v252, v251, 4, v250
    v_add_u32 v251, 4, v249
    v_xor_b32 v251, v251, v248
    v_lshl_add_u32 v253, v251, 4, v250
    v_add_u32 v251, 8, v249
    v_xor_b32 v251, v251, v248
    v_lshl_add_u32 v254, v251, 4, v250
    v_add_u32 v251, 12, v249
    v_xor_b32 v251, v251, v248
    v_lshl_add_u32 v255, v251, 4, v250
    ds_read_b128 v[32:35], v252 offset:0
    ds_read_b128 v[36:39], v253 offset:0
    ds_read_b128 v[40:43], v254 offset:0
    ds_read_b128 v[44:47], v255 offset:0
    ds_read_b128 v[48:51], v252 offset:4096
    ds_read_b128 v[52:55], v253 offset:4096
    ds_read_b128 v[56:59], v254 offset:4096
    ds_read_b128 v[60:63], v255 offset:4096
    ds_read_b128 v[64:67], v252 offset:8192
    ds_read_b128 v[68:71], v253 offset:8192
    ds_read_b128 v[72:75], v254 offset:8192
    ds_read_b128 v[76:79], v255 offset:8192
    ds_read_b128 v[80:83], v252 offset:12288
    ds_read_b128 v[84:87], v253 offset:12288
    ds_read_b128 v[88:91], v254 offset:12288
    ds_read_b128 v[92:95], v255 offset:12288
    ds_read_b128 v[96:99], v252 offset:16384
    ds_read_b128 v[100:103], v253 offset:16384
    ds_read_b128 v[104:107], v254 offset:16384
    ds_read_b128 v[108:111], v255 offset:16384
    s_waitcnt lgkmcnt(0)
    v_mfma_f32_16x16x32_bf16 v[192:195], v[32:35], v[16:19], 0
    v_mfma_f32_16x16x32_bf16 v[196:199], v[48:51], v[16:19], 0
    v_mfma_f32_16x16x32_bf16 v[200:203], v[64:67], v[16:19], 0
    v_mfma_f32_16x16x32_bf16 v[204:207], v[80:83], v[16:19], 0
    v_mfma_f32_16x16x32_bf16 v[208:211], v[96:99], v[16:19], 0
    v_mfma_f32_16x16x32_bf16 v[192:195], v[36:39], v[20:23], v[192:195]
    v_mfma_f32_16x16x32_bf16 v[196:199], v[52:55], v[20:23], v[196:199]
    v_mfma_f32_16x16x32_bf16 v[200:203], v[68:71], v[20:23], v[200:203]
    v_mfma_f32_16x16x32_bf16 v[204:207], v[84:87], v[20:23], v[204:207]
    v_mfma_f32_16x16x32_bf16 v[208:211], v[100:103], v[20:23], v[208:211]
    v_mfma_f32_16x16x32_bf16 v[192:195], v[40:43], v[24:27], v[192:195]
    v_mfma_f32_16x16x32_bf16 v[196:199], v[56:59], v[24:27], v[196:199]
    v_mfma_f32_16x16x32_bf16 v[200:203], v[72:75], v[24:27], v[200:203]
    v_mfma_f32_16x16x32_bf16 v[204:207], v[88:91], v[24:27], v[204:207]
    v_mfma_f32_16x16x32_bf16 v[208:211], v[104:107], v[24:27], v[208:211]
    v_mfma_f32_16x16x32_bf16 v[192:195], v[44:47], v[28:31], v[192:195]
    v_mfma_f32_16x16x32_bf16 v[196:199], v[60:63], v[28:31], v[196:199]
    v_mfma_f32_16x16x32_bf16 v[200:203], v[76:79], v[28:31], v[200:203]
    v_mfma_f32_16x16x32_bf16 v[204:207], v[92:95], v[28:31], v[204:207]
    v_mfma_f32_16x16x32_bf16 v[208:211], v[108:111], v[28:31], v[208:211]
    s_nop 3
    v_cvt_pk_bf16_f32 v212, v192, v193
    v_cvt_pk_bf16_f32 v213, v194, v195
    v_cvt_pk_bf16_f32 v214, v196, v197
    v_cvt_pk_bf16_f32 v215, v198, v199
    v_cvt_pk_bf16_f32 v216, v200, v201
    v_cvt_pk_bf16_f32 v217, v202, v203
    v_cvt_pk_bf16_f32 v218, v204, v205
    v_cvt_pk_bf16_f32 v219, v206, v207
    v_cvt_pk_bf16_f32 v220, v208, v209
    v_cvt_pk_bf16_f32 v221, v210, v211
    v_lshlrev_b32 v192, 16, v212
    v_and_b32 v193, s75, v212
    v_lshlrev_b32 v194, 16, v213
    v_and_b32 v195, s75, v213
    v_lshlrev_b32 v196, 16, v214
    v_and_b32 v197, s75, v214
    v_lshlrev_b32 v198, 16, v215
    v_and_b32 v199, s75, v215
    v_lshlrev_b32 v200, 16, v216
    v_and_b32 v201, s75, v216
    v_lshlrev_b32 v202, 16, v217
    v_and_b32 v203, s75, v217
    v_lshlrev_b32 v204, 16, v218
    v_and_b32 v205, s75, v218
    v_lshlrev_b32 v206, 16, v219
    v_and_b32 v207, s75, v219
    v_lshlrev_b32 v208, 16, v220
    v_and_b32 v209, s75, v220
    v_lshlrev_b32 v210, 16, v221
    v_and_b32 v211, s75, v221
    v_mul_f32 v192, s70, v192
    v_mul_f32 v193, s70, v193
    v_mul_f32 v194, s70, v194
    v_mul_f32 v195, s70, v195
    v_mul_f32 v196, s70, v196
    v_mul_f32 v197, s70, v197
    v_mul_f32 v198, s70, v198
    v_mul_f32 v199, s70, v199
    v_mul_f32 v200, s70, v200
    v_mul_f32 v201, s70, v201
    v_mul_f32 v202, s70, v202
    v_mul_f32 v203, s70, v203
    v_mul_f32 v204, s70, v204
    v_mul_f32 v205, s70, v205
    v_mul_f32 v206, s70, v206
    v_mul_f32 v207, s70, v207
    v_mul_f32 v208, s70, v208
    v_mul_f32 v209, s70, v209
    v_mul_f32 v210, s70, v210
    v_mul_f32 v211, s70, v211
    v_cvt_pk_bf16_f32 v212, v192, v193
    v_cvt_pk_bf16_f32 v213, v194, v195
    v_cvt_pk_bf16_f32 v214, v196, v197
    v_cvt_pk_bf16_f32 v215, v198, v199
    v_cvt_pk_bf16_f32 v216, v200, v201
    v_cvt_pk_bf16_f32 v217, v202, v203
    v_cvt_pk_bf16_f32 v218, v204, v205
    v_cvt_pk_bf16_f32 v219, v206, v207
    v_cvt_pk_bf16_f32 v220, v208, v209
    v_cvt_pk_bf16_f32 v221, v210, v211
    v_lshlrev_b32 v192, 16, v212
    v_and_b32 v193, s75, v212
    v_lshlrev_b32 v194, 16, v213
    v_and_b32 v195, s75, v213
    v_lshlrev_b32 v196, 16, v214
    v_and_b32 v197, s75, v214
    v_lshlrev_b32 v198, 16, v215
    v_and_b32 v199, s75, v215
    v_lshlrev_b32 v200, 16, v216
    v_and_b32 v201, s75, v216
    v_lshlrev_b32 v202, 16, v217
    v_and_b32 v203, s75, v217
    v_lshlrev_b32 v204, 16, v218
    v_and_b32 v205, s75, v218
    v_lshlrev_b32 v206, 16, v219
    v_and_b32 v207, s75, v219
    v_lshlrev_b32 v208, 16, v220
    v_and_b32 v209, s75, v220
    v_lshlrev_b32 v210, 16, v221
    v_and_b32 v211, s75, v221
    v_max3_f32 v212, v192, v193, v194
    v_max3_f32 v213, v195, v196, v197
    v_max3_f32 v214, v198, v199, v200
    v_max3_f32 v215, v201, v202, v203
    v_max3_f32 v216, v204, v205, v206
    v_max3_f32 v217, v207, v208, v209
    v_max3_f32 v218, v212, v213, v214
    v_max3_f32 v219, v215, v216, v217
    v_max3_f32 v220, v218, v219, v210
    v_max_f32 v221, v220, v211
    v_mov_b32 v222, v221
    v_mov_b32 v212, v222
    s_nop 1
    v_permlane16_swap_b32 v222, v212
    v_max_f32 v222, v222, v212
    v_mov_b32 v212, v222
    s_nop 1
    v_permlane32_swap_b32 v222, v212
    v_max_f32 v222, v222, v212
    v_sub_f32 v192, v192, v222
    v_sub_f32 v193, v193, v222
    v_sub_f32 v194, v194, v222
    v_sub_f32 v195, v195, v222
    v_sub_f32 v196, v196, v222
    v_sub_f32 v197, v197, v222
    v_sub_f32 v198, v198, v222
    v_sub_f32 v199, v199, v222
    v_sub_f32 v200, v200, v222
    v_sub_f32 v201, v201, v222
    v_sub_f32 v202, v202, v222
    v_sub_f32 v203, v203, v222
    v_sub_f32 v204, v204, v222
    v_sub_f32 v205, v205, v222
    v_sub_f32 v206, v206, v222
    v_sub_f32 v207, v207, v222
    v_sub_f32 v208, v208, v222
    v_sub_f32 v209, v209, v222
    v_sub_f32 v210, v210, v222
    v_sub_f32 v211, v211, v222
    v_mul_f32 v192, s71, v192
    v_mul_f32 v193, s71, v193
    v_mul_f32 v194, s71, v194
    v_mul_f32 v195, s71, v195
    v_mul_f32 v196, s71, v196
    v_mul_f32 v197, s71, v197
    v_mul_f32 v198, s71, v198
    v_mul_f32 v199, s71, v199
    v_mul_f32 v200, s71, v200
    v_mul_f32 v201, s71, v201
    v_mul_f32 v202, s71, v202
    v_mul_f32 v203, s71, v203
    v_mul_f32 v204, s71, v204
    v_mul_f32 v205, s71, v205
    v_mul_f32 v206, s71, v206
    v_mul_f32 v207, s71, v207
    v_mul_f32 v208, s71, v208
    v_mul_f32 v209, s71, v209
    v_mul_f32 v210, s71, v210
    v_mul_f32 v211, s71, v211
    v_exp_f32 v192, v192
    v_exp_f32 v193, v193
    v_exp_f32 v194, v194
    v_exp_f32 v195, v195
    v_exp_f32 v196, v196
    v_exp_f32 v197, v197
    v_exp_f32 v198, v198
    v_exp_f32 v199, v199
    v_exp_f32 v200, v200
    v_exp_f32 v201, v201
    v_exp_f32 v202, v202
    v_exp_f32 v203, v203
    v_exp_f32 v204, v204
    v_exp_f32 v205, v205
    v_exp_f32 v206, v206
    v_exp_f32 v207, v207
    v_exp_f32 v208, v208
    v_exp_f32 v209, v209
    v_exp_f32 v210, v210
    v_exp_f32 v211, v211
    v_add_f32 v212, v192, v193
    v_add_f32 v213, v194, v195
    v_add_f32 v214, v196, v197
    v_add_f32 v215, v198, v199
    v_add_f32 v216, v200, v201
    v_add_f32 v217, v202, v203
    v_add_f32 v218, v204, v205
    v_add_f32 v219, v206, v207
    v_add_f32 v220, v208, v209
    v_add_f32 v221, v210, v211
    v_add_f32 v212, v212, v221
    v_add_f32 v213, v213, v220
    v_add_f32 v214, v214, v219
    v_add_f32 v215, v215, v218
    v_add_f32 v216, v216, v217
    v_add_f32 v212, v212, v216
    v_add_f32 v213, v213, v215
    v_add_f32 v212, v212, v214
    v_add_f32 v212, v212, v213
    v_mov_b32 v223, v212
    v_mov_b32 v212, v223
    s_nop 1
    v_permlane16_swap_b32 v223, v212
    v_add_f32 v223, v223, v212
    v_mov_b32 v212, v223
    s_nop 1
    v_permlane32_swap_b32 v223, v212
    v_add_f32 v223, v223, v212
    v_cvt_pk_bf16_f32 v192, v192, v192
    v_cvt_pk_bf16_f32 v193, v193, v193
    v_cvt_pk_bf16_f32 v194, v194, v194
    v_cvt_pk_bf16_f32 v195, v195, v195
    v_cvt_pk_bf16_f32 v196, v196, v196
    v_cvt_pk_bf16_f32 v197, v197, v197
    v_cvt_pk_bf16_f32 v198, v198, v198
    v_cvt_pk_bf16_f32 v199, v199, v199
    v_cvt_pk_bf16_f32 v200, v200, v200
    v_cvt_pk_bf16_f32 v201, v201, v201
    v_cvt_pk_bf16_f32 v202, v202, v202
    v_cvt_pk_bf16_f32 v203, v203, v203
    v_cvt_pk_bf16_f32 v204, v204, v204
    v_cvt_pk_bf16_f32 v205, v205, v205
    v_cvt_pk_bf16_f32 v206, v206, v206
    v_cvt_pk_bf16_f32 v207, v207, v207
    v_cvt_pk_bf16_f32 v208, v208, v208
    v_cvt_pk_bf16_f32 v209, v209, v209
    v_cvt_pk_bf16_f32 v210, v210, v210
    v_cvt_pk_bf16_f32 v211, v211, v211
    v_and_b32 v32, v192, v8
    v_and_b32 v33, v192, v9
    v_and_b32 v34, v192, v10
    v_and_b32 v35, v192, v11
    v_and_b32 v36, v193, v8
    v_and_b32 v37, v193, v9
    v_and_b32 v38, v193, v10
    v_and_b32 v39, v193, v11
    v_and_b32 v40, v194, v8
    v_and_b32 v41, v194, v9
    v_and_b32 v42, v194, v10
    v_and_b32 v43, v194, v11
    v_and_b32 v44, v195, v8
    v_and_b32 v45, v195, v9
    v_and_b32 v46, v195, v10
    v_and_b32 v47, v195, v11
    v_and_b32 v48, v196, v8
    v_and_b32 v49, v196, v9
    v_and_b32 v50, v196, v10
    v_and_b32 v51, v196, v11
    v_and_b32 v52, v197, v8
    v_and_b32 v53, v197, v9
    v_and_b32 v54, v197, v10
    v_and_b32 v55, v197, v11
    v_and_b32 v56, v198, v8
    v_and_b32 v57, v198, v9
    v_and_b32 v58, v198, v10
    v_and_b32 v59, v198, v11
    v_and_b32 v60, v199, v8
    v_and_b32 v61, v199, v9
    v_and_b32 v62, v199, v10
    v_and_b32 v63, v199, v11
    v_and_b32 v64, v200, v8
    v_and_b32 v65, v200, v9
    v_and_b32 v66, v200, v10
    v_and_b32 v67, v200, v11
    v_and_b32 v68, v201, v8
    v_and_b32 v69, v201, v9
    v_and_b32 v70, v201, v10
    v_and_b32 v71, v201, v11
    v_and_b32 v72, v202, v8
    v_and_b32 v73, v202, v9
    v_and_b32 v74, v202, v10
    v_and_b32 v75, v202, v11
    v_and_b32 v76, v203, v8
    v_and_b32 v77, v203, v9
    v_and_b32 v78, v203, v10
    v_and_b32 v79, v203, v11
    v_and_b32 v80, v204, v8
    v_and_b32 v81, v204, v9
    v_and_b32 v82, v204, v10
    v_and_b32 v83, v204, v11
    v_and_b32 v84, v205, v8
    v_and_b32 v85, v205, v9
    v_and_b32 v86, v205, v10
    v_and_b32 v87, v205, v11
    v_and_b32 v88, v206, v8
    v_and_b32 v89, v206, v9
    v_and_b32 v90, v206, v10
    v_and_b32 v91, v206, v11
    v_and_b32 v92, v207, v8
    v_and_b32 v93, v207, v9
    v_and_b32 v94, v207, v10
    v_and_b32 v95, v207, v11
    v_and_b32 v96, v208, v8
    v_and_b32 v97, v208, v9
    v_and_b32 v98, v208, v10
    v_and_b32 v99, v208, v11
    v_and_b32 v100, v209, v8
    v_and_b32 v101, v209, v9
    v_and_b32 v102, v209, v10
    v_and_b32 v103, v209, v11
    v_and_b32 v104, v210, v8
    v_and_b32 v105, v210, v9
    v_and_b32 v106, v210, v10
    v_and_b32 v107, v210, v11
    v_and_b32 v108, v211, v8
    v_and_b32 v109, v211, v9
    v_and_b32 v110, v211, v10
    v_and_b32 v111, v211, v11
    s_setprio 2
    v_mfma_f32_16x16x32_bf16 v[12:15], v[112:115], v[32:35], 0
    v_mfma_f32_16x16x32_bf16 v[12:15], v[116:119], v[36:39], v[12:15]
    v_mfma_f32_16x16x32_bf16 v[12:15], v[120:123], v[40:43], v[12:15]
    v_mfma_f32_16x16x32_bf16 v[12:15], v[124:127], v[44:47], v[12:15]
    v_mfma_f32_16x16x32_bf16 v[12:15], v[128:131], v[48:51], v[12:15]
    v_mfma_f32_16x16x32_bf16 v[12:15], v[132:135], v[52:55], v[12:15]
    v_mfma_f32_16x16x32_bf16 v[12:15], v[136:139], v[56:59], v[12:15]
    v_mfma_f32_16x16x32_bf16 v[12:15], v[140:143], v[60:63], v[12:15]
    v_mfma_f32_16x16x32_bf16 v[12:15], v[144:147], v[64:67], v[12:15]
    v_mfma_f32_16x16x32_bf16 v[12:15], v[148:151], v[68:71], v[12:15]
    v_mfma_f32_16x16x32_bf16 v[12:15], v[152:155], v[72:75], v[12:15]
    v_mfma_f32_16x16x32_bf16 v[12:15], v[156:159], v[76:79], v[12:15]
    s_waitcnt vmcnt(7)
    v_mfma_f32_16x16x32_bf16 v[12:15], v[160:163], v[80:83], v[12:15]
    s_waitcnt vmcnt(6)
    v_mfma_f32_16x16x32_bf16 v[12:15], v[164:167], v[84:87], v[12:15]
    s_waitcnt vmcnt(5)
    v_mfma_f32_16x16x32_bf16 v[12:15], v[168:171], v[88:91], v[12:15]
    s_waitcnt vmcnt(4)
    v_mfma_f32_16x16x32_bf16 v[12:15], v[172:175], v[92:95], v[12:15]
    s_waitcnt vmcnt(3)
    v_mfma_f32_16x16x32_bf16 v[12:15], v[176:179], v[96:99], v[12:15]
    s_waitcnt vmcnt(2)
    v_mfma_f32_16x16x32_bf16 v[12:15], v[180:183], v[100:103], v[12:15]
    s_waitcnt vmcnt(1)
    v_mfma_f32_16x16x32_bf16 v[12:15], v[184:187], v[104:107], v[12:15]
    s_waitcnt vmcnt(0)
    v_mfma_f32_16x16x32_bf16 v[12:15], v[188:191], v[108:111], v[12:15]
    s_setprio 3
    s_lshl_b32 s65, s28, 10
    v_add_u32 v248, s65, v2
    s_lshl_b32 s65, s28, 4
    v_and_b32 v249, 8, v1
    v_add_u32 v249, s65, v249
    s_nop 1
    ds_write_b128 v248, v[12:15] offset:12800
    s_mov_b64 exec, 0x101
    ds_write_b64 v249, v[222:223] offset:2624
    s_mov_b64 exec, -1
    s_waitcnt lgkmcnt(0)
    s_barrier
    s_cmp_eq_u32 s28, 4
    s_cbranch_scc1 L_h2go
    v_mov_b32 v255, 2568
L_lw_s4:
    ds_read_b32 v254, v255
    s_waitcnt lgkmcnt(0)
    v_readfirstlane_b32 s68, v254
    s_cmp_ge_u32 s68, 4
    s_cbranch_scc1 L_lwok_s4
    s_sleep 1
    s_branch L_lw_s4
L_lwok_s4:
    v_subrev_u32 v252, 320, v0
    v_min_u32 v248, 287, v252
    v_lshlrev_b32 v248, 3, v248
    ds_read_b64 v[32:33], v248 offset:39680
    ds_read_b64 v[34:35], v248 offset:41984
    ds_read_b64 v[36:37], v248 offset:44288
    v_lshrrev_b32 v250, 2, v252
    v_and_b32 v251, 3, v252
    v_lshlrev_b32 v251, 4, v251
    v_lshl_add_u32 v250, v250, 15, v251
    v_mov_b32 v251, 0x80000000
    v_cmp_gt_u32 vcc, 288, v252
    s_nop 1
    v_cndmask_b32 v250, v251, v250, vcc
    s_lshl_b32 s65, s2, 6
    s_add_u32 s65, s65, 4210688
    s_waitcnt lgkmcnt(0)
    v_add_f32 v32, v32, v34
    v_add_f32 v40, v32, v36
    v_add_f32 v33, v33, v35
    v_add_f32 v42, v33, v37
    v_mov_b32 v41, s31
    v_mov_b32 v43, s31
    buffer_store_dwordx4 v[40:43], v250, s[48:51], s65 offen sc1
    s_cmp_ge_u32 s28, 7
    s_cbranch_scc1 L_h2wait
    v_subrev_u32 v252, 128, v0
    v_min_u32 v248, 287, v252
    v_lshlrev_b32 v248, 3, v248
    ds_read_b64 v[32:33], v248 offset:39680
    ds_read_b64 v[34:35], v248 offset:41984
    ds_read_b64 v[36:37], v248 offset:44288
    v_lshrrev_b32 v250, 2, v252
    v_and_b32 v251, 3, v252
    v_lshlrev_b32 v251, 4, v251
    v_lshl_add_u32 v250, v250, 15, v251
    v_mov_b32 v251, 0x80000000
    v_cmp_gt_u32 vcc, 288, v252
    s_nop 1
    v_cndmask_b32 v250, v251, v250, vcc
    s_lshl_b32 s65, s2, 6
    s_add_u32 s65, s65, 4210688
    s_waitcnt lgkmcnt(0)
    v_add_f32 v32, v32, v34
    v_add_f32 v40, v32, v36
    v_add_f32 v33, v33, v35
    v_add_f32 v42, v33, v37
    v_mov_b32 v41, s31
    v_mov_b32 v43, s31
    buffer_store_dwordx4 v[40:43], v250, s[48:51], s65 offen sc1
    s_branch L_h2wait
L_h2go:
    s_nop 7
    s_nop 1
    v_and_b32 v248, 15, v1
    v_lshlrev_b32 v248, 8, v248
    v_lshrrev_b32 v249, 4, v1
    v_lshl_add_u32 v249, v249, 4, v248
    s_lshl_b32 s65, s29, 16
    s_add_u32 s65, s65, 4096
    s_lshl_b32 s66, s30, 12
    s_add_u32 s66, s66, s65
    s_mov_b32 s74, 0x100000
    s_mov_b32 s85, s66
L_h2poll:
    s_nop 7
    s_nop 1
    s_and_b32 s67, s74, 31
    s_cmp_eq_u32 s67, 1
    s_cselect_b32 s67, 0, 8388608
    s_add_u32 s66, s85, s67
    buffer_load_dwordx4 v[112:115], v249, s[48:51], s66 offen sc1
    buffer_load_dwordx4 v[116:119], v249, s[48:51], s66 offen offset:64 sc1
    buffer_load_dwordx4 v[120:123], v248, s[48:51], s66 offen offset:128 sc1
    s_waitcnt vmcnt(0)
    v_cmp_ne_u32 vcc, s31, v113
    v_cmp_ne_u32 s[78:79], s31, v115
    s_or_b64 vcc, vcc, s[78:79]
    v_cmp_ne_u32 s[78:79], s31, v117
    s_or_b64 vcc, vcc, s[78:79]
    v_cmp_ne_u32 s[78:79], s31, v119
    s_or_b64 vcc, vcc, s[78:79]
    v_cmp_ne_u32 s[78:79], s31, v121
    s_or_b64 vcc, vcc, s[78:79]
    v_cmp_ne_u32 s[78:79], s31, v123
    s_or_b64 vcc, vcc, s[78:79]
    s_cmp_eq_u64 vcc, 0
    s_cbranch_scc1 L_h2ok
    s_sleep 1
    s_sub_u32 s74, s74, 1
    s_cmp_lg_u32 s74, 0
    s_cbranch_scc1 L_h2poll
L_h2ok:
    s_nop 7
    s_nop 1
    v_mov_b32 v124, v120
    s_nop 1
    v_max_f32 v124, v124, v124 row_ror:8
    s_nop 1
    v_max_f32 v124, v124, v124 row_ror:4
    s_nop 1
    v_max_f32 v124, v124, v124 row_ror:2
    s_nop 1
    v_max_f32 v124, v124, v124 row_ror:1
    v_sub_f32 v124, v120, v124
    v_mul_f32 v124, s71, v124
    v_exp_f32 v124, v124
    s_nop 0
    v_mul_f32 v128, v124, v112
    v_mul_f32 v129, v124, v114
    v_mul_f32 v130, v124, v116
    v_mul_f32 v131, v124, v118
    v_mul_f32 v132, v124, v122
    v_add_f32 v128, v128, v128 row_ror:8
    v_add_f32 v129, v129, v129 row_ror:8
    v_add_f32 v130, v130, v130 row_ror:8
    v_add_f32 v131, v131, v131 row_ror:8
    v_add_f32 v132, v132, v132 row_ror:8
    v_add_f32 v128, v128, v128 row_ror:4
    v_add_f32 v129, v129, v129 row_ror:4
    v_add_f32 v130, v130, v130 row_ror:4
    v_add_f32 v131, v131, v131 row_ror:4
    v_add_f32 v132, v132, v132 row_ror:4
    v_add_f32 v128, v128, v128 row_ror:2
    v_add_f32 v129, v129, v129 row_ror:2
    v_add_f32 v130, v130, v130 row_ror:2
    v_add_f32 v131, v131, v131 row_ror:2
    v_add_f32 v132, v132, v132 row_ror:2
    v_add_f32 v128, v128, v128 row_ror:1
    v_add_f32 v129, v129, v129 row_ror:1
    v_add_f32 v130, v130, v130 row_ror:1
    v_add_f32 v131, v131, v131 row_ror:1
    v_add_f32 v132, v132, v132 row_ror:1
    v_rcp_f32 v133, v132
    s_nop 0
    v_mul_f32 v136, v128, v133
    v_mul_f32 v137, v129, v133
    v_mul_f32 v138, v130, v133
    v_mul_f32 v139, v131, v133
    v_fma_f32 v128, -v136, v132, v128
    v_fma_f32 v129, -v137, v132, v129
    v_fma_f32 v130, -v138, v132, v130
    v_fma_f32 v131, -v139, v132, v131
    v_fmac_f32 v136, v128, v133
    v_fmac_f32 v137, v129, v133
    v_fmac_f32 v138, v130, v133
    v_fmac_f32 v139, v131, v133
    v_cvt_pk_bf16_f32 v250, v136, v137
    v_lshlrev_b32 v136, 16, v250
    v_and_b32 v137, s75, v250
    v_cvt_pk_bf16_f32 v250, v138, v139
    v_lshlrev_b32 v138, 16, v250
    v_and_b32 v139, s75, v250
    v_lshrrev_b32 v248, 4, v1
    v_lshlrev_b32 v248, 3, v248
    v_mov_b32 v140, 0
    v_mov_b32 v141, 0
    s_mov_b32 exec_lo, 0x00010001
    s_mov_b32 exec_hi, 0x00010001
    ds_write_b64 v248, v[136:137] offset:3584
    ds_write_b64 v248, v[138:139] offset:3616
    s_mov_b64 exec, 1
    ds_write_b64 v248, v[140:141] offset:3648
    s_mov_b64 exec, -1
    s_waitcnt lgkmcnt(0)
L_h2wait:
    s_nop 7
    s_nop 1
    s_barrier
    s_barrier
    s_cmp_lg_u32 s28, 4
    s_cbranch_scc1 L_tail
    v_subrev_u32 v252, 0, v0
    v_min_u32 v248, 287, v252
    v_lshlrev_b32 v248, 3, v248
    ds_read_b64 v[32:33], v248 offset:32768
    ds_read_b64 v[34:35], v248 offset:35072
    ds_read_b64 v[36:37], v248 offset:37376
    v_lshrrev_b32 v250, 2, v252
    v_and_b32 v251, 3, v252
    v_lshlrev_b32 v251, 4, v251
    v_lshl_add_u32 v250, v250, 15, v251
    v_mov_b32 v251, 0x80000000
    v_cmp_gt_u32 vcc, 288, v252
    s_nop 1
    v_cndmask_b32 v250, v251, v250, vcc
    s_lshl_b32 s65, s2, 6
    s_add_u32 s65, s65, 4194304
    s_waitcnt lgkmcnt(0)
    v_add_f32 v32, v32, v34
    v_add_f32 v40, v32, v36
    v_add_f32 v33, v33, v35
    v_add_f32 v42, v33, v37
    v_mov_b32 v41, s31
    v_mov_b32 v43, s31
    buffer_store_dwordx4 v[40:43], v250, s[48:51], s65 offen sc1
L_tail:
    s_nop 7
    s_nop 1
    s_cmp_ge_u32 s2, 72
    s_cbranch_scc1 L_end_stamp
    s_mov_b32 s32, s4
    s_and_b32 s33, s5, 0xffff
    s_mov_b32 s34, 0x480
    s_mov_b32 s35, 0x20000
    s_mov_b32 s56, s22
    s_and_b32 s57, s23, 0xffff
    s_mov_b32 s58, 0x480
    s_mov_b32 s59, 0x20000
    v_lshlrev_b32 v248, 4, v0
    s_lshl_b32 s65, s2, 15
    s_add_u32 s65, s65, 4194304
    s_add_u32 s66, s65, 8192
    s_add_u32 s67, s65, 16384
    s_add_u32 s68, s65, 24576
    v_and_b32 v249, 3, v1
    v_lshlrev_b32 v249, 2, v249
    s_lshl_b32 s76, s2, 4
    v_add_u32 v249, s76, v249
    buffer_load_dword v224, v249, s[32:35], 0 offen
    s_mov_b32 s74, 0x100000
L_redpoll0:
    s_nop 7
    s_nop 1
    buffer_load_dwordx4 v[40:43], v248, s[48:51], s67 offen sc1
    buffer_load_dwordx4 v[44:47], v248, s[48:51], s68 offen sc1
    s_waitcnt vmcnt(0)
    v_cmp_ne_u32 vcc, s31, v41
    v_cmp_ne_u32 s[78:79], s31, v43
    s_or_b64 vcc, vcc, s[78:79]
    v_cmp_ne_u32 s[78:79], s31, v45
    s_or_b64 vcc, vcc, s[78:79]
    v_cmp_ne_u32 s[78:79], s31, v47
    s_or_b64 vcc, vcc, s[78:79]
    s_cmp_eq_u64 vcc, 0
    s_cbranch_scc1 L_redok0
    s_sleep 1
    s_sub_u32 s74, s74, 1
    s_cmp_lg_u32 s74, 0
    s_cbranch_scc1 L_redpoll0
L_redok0:
L_redpoll1:
    s_nop 7
    s_nop 1
    buffer_load_dwordx4 v[32:35], v248, s[48:51], s65 offen sc1
    buffer_load_dwordx4 v[36:39], v248, s[48:51], s66 offen sc1
    s_waitcnt vmcnt(0)
    v_cmp_ne_u32 vcc, s31, v33
    v_cmp_ne_u32 s[78:79], s31, v35
    s_or_b64 vcc, vcc, s[78:79]
    v_cmp_ne_u32 s[78:79], s31, v37
    s_or_b64 vcc, vcc, s[78:79]
    v_cmp_ne_u32 s[78:79], s31, v39
    s_or_b64 vcc, vcc, s[78:79]
    s_cmp_eq_u64 vcc, 0
    s_cbranch_scc1 L_redok1
    s_sleep 1
    s_sub_u32 s74, s74, 1
    s_cmp_lg_u32 s74, 0
    s_cbranch_scc1 L_redpoll1
L_redok1:
L_redok:
    s_nop 7
    s_nop 1
    v_add_f32 v48, v32, v36
    v_add_f32 v49, v34, v38
    v_add_f32 v50, v40, v44
    v_add_f32 v51, v42, v46
    v_add_f32 v48, v48, v48 row_ror:8
    v_add_f32 v49, v49, v49 row_ror:8
    v_add_f32 v50, v50, v50 row_ror:8
    v_add_f32 v51, v51, v51 row_ror:8
    v_add_f32 v48, v48, v48 row_ror:4
    v_add_f32 v49, v49, v49 row_ror:4
    v_add_f32 v50, v50, v50 row_ror:4
    v_add_f32 v51, v51, v51 row_ror:4
    v_mov_b32 v52, v48
    v_mov_b32 v53, v49
    v_mov_b32 v54, v50
    v_mov_b32 v55, v51
    v_permlane16_swap_b32 v48, v52
    v_permlane16_swap_b32 v49, v53
    v_permlane16_swap_b32 v50, v54
    v_permlane16_swap_b32 v51, v55
    v_add_f32 v48, v48, v52
    v_add_f32 v49, v49, v53
    v_add_f32 v50, v50, v54
    v_add_f32 v51, v51, v55
    v_mov_b32 v52, v48
    v_mov_b32 v53, v49
    v_mov_b32 v54, v50
    v_mov_b32 v55, v51
    v_permlane32_swap_b32 v48, v52
    v_permlane32_swap_b32 v49, v53
    v_permlane32_swap_b32 v50, v54
    v_permlane32_swap_b32 v51, v55
    v_add_f32 v48, v48, v52
    v_add_f32 v49, v49, v53
    v_add_f32 v50, v50, v54
    v_add_f32 v51, v51, v55
    s_lshl_b32 s65, s28, 6
    v_add_u32 v248, s65, v2
    s_mov_b64 exec, 0xf
    ds_write_b128 v248, v[48:51] offset:3840
    s_mov_b64 exec, -1
    s_waitcnt lgkmcnt(0)
    s_barrier
    s_cmp_lg_u32 s28, 0
    s_cbranch_scc1 L_end_stamp
    v_and_b32 v248, 3, v1
    v_lshlrev_b32 v248, 4, v248
    ds_read_b128 v[32:35], v248 offset:3840
    ds_read_b128 v[36:39], v248 offset:3904
    ds_read_b128 v[40:43], v248 offset:3968
    ds_read_b128 v[44:47], v248 offset:4032
    ds_read_b128 v[48:51], v248 offset:4096
    ds_read_b128 v[52:55], v248 offset:4160
    ds_read_b128 v[56:59], v248 offset:4224
    ds_read_b128 v[60:63], v248 offset:4288
    s_waitcnt lgkmcnt(0)
    v_add_f32 v32, v32, v48
    v_add_f32 v33, v33, v49
    v_add_f32 v34, v34, v50
    v_add_f32 v35, v35, v51
    v_add_f32 v36, v36, v52
    v_add_f32 v37, v37, v53
    v_add_f32 v38, v38, v54
    v_add_f32 v39, v39, v55
    v_add_f32 v40, v40, v56
    v_add_f32 v41, v41, v57
    v_add_f32 v42, v42, v58
    v_add_f32 v43, v43, v59
    v_add_f32 v44, v44, v60
    v_add_f32 v45, v45, v61
    v_add_f32 v46, v46, v62
    v_add_f32 v47, v47, v63
    v_add_f32 v32, v32, v40
    v_add_f32 v33, v33, v41
    v_add_f32 v34, v34, v42
    v_add_f32 v35, v35, v43
    v_add_f32 v36, v36, v44
    v_add_f32 v37, v37, v45
    v_add_f32 v38, v38, v46
    v_add_f32 v39, v39, v47
    v_add_f32 v32, v32, v36
    v_add_f32 v33, v33, v37
    v_add_f32 v34, v34, v38
    v_add_f32 v35, v35, v39
    v_cvt_pk_bf16_f32 v251, v32, v33
    v_lshlrev_b32 v32, 16, v251
    v_and_b32 v33, s75, v251
    v_cvt_pk_bf16_f32 v251, v34, v35
    v_lshlrev_b32 v34, 16, v251
    v_and_b32 v35, s75, v251
    v_lshlrev_b32 v36, 16, v224
    v_and_b32 v37, s75, v224
    v_add_f32 v32, v32, v36
    v_add_f32 v33, v33, v37
    v_cvt_pk_bf16_f32 v251, v32, v33
    v_lshlrev_b32 v32, 16, v251
    v_and_b32 v33, s75, v251
    v_add_f32 v32, v32, v34
    v_add_f32 v33, v33, v35
    v_cvt_pk_bf16_f32 v32, v32, v33
    s_mov_b64 exec, 0xf
    buffer_store_dword v32, v249, s[56:59], 0 offen
    s_cmp_lg_u32 s2, 0
    s_cbranch_scc1 L_noep
    s_mov_b64 exec, 1
    v_mov_b32 v33, s31
    v_mov_b32 v34, 0
    buffer_store_dword v33, v34, s[48:51], 0 offen
L_noep:
    s_mov_b64 exec, -1
L_end_stamp:
    s_nop 7
    s_nop 1
L_end:
    s_endpgm
.section .rodata,"a"
.p2align 6
.amdhsa_kernel parallel_sum__gqa_block_cached__swiglu_ffn__decode_kernel
  .amdhsa_next_free_vgpr 256
  .amdhsa_next_free_sgpr 100
  .amdhsa_accum_offset 256
  .amdhsa_group_segment_fixed_size 0
  .amdhsa_kernarg_size 96
  .amdhsa_user_sgpr_count 2
  .amdhsa_user_sgpr_kernarg_segment_ptr 1
  .amdhsa_system_sgpr_workgroup_id_x 1
  .amdhsa_float_denorm_mode_32 3
.end_amdhsa_kernel
```
